```python
import torch

def _softmax(x, axis=-1):
    return torch.softmax(x, dim=axis)
def _gelu(x):
    return torch.nn.functional.gelu(x, approximate="tanh")
def _silu(x):
    return torch.nn.functional.silu(x)
def _sigmoid(x):
    return torch.sigmoid(x)
def _layernorm(x, axis=-1, eps=1e-5):
    m = x.mean(dim=axis, keepdim=True)
    v = x.var(dim=axis, keepdim=True, unbiased=False)
    return (x - m) / torch.sqrt(v + eps)
def _scatter_add(tgt, idx, src, axis=0):
    return tgt.clone().index_add_(axis, idx, src)
def _segment_sum(src, seg, n):
    out = torch.zeros((n,) + src.shape[1:], dtype=src.dtype)
    return out.index_add_(0, seg, src)
def _pad(x, pw):
    flat = tuple(v for pair in reversed(pw) for v in pair)
    return torch.nn.functional.pad(x, flat)

kernel_name = 'parallel_sum__ssm_conv_h3__glu_gated_swiglu__prompt'

def setup_inputs():

    _w = (lambda a: (lambda t: t.to(torch.bfloat16) if t.is_floating_point() else t)(torch.as_tensor(a)))
    def _A_setup():
        B, S, D = 1, 2048, 448
        ks = 4
        return {
            "q": _w((lambda *s: torch.randn(*s, dtype=torch.bfloat16) * 0.05)(B, S, D)),
            "k": _w((lambda *s: torch.randn(*s, dtype=torch.bfloat16) * 0.2)(B, S, D)),
            "v": _w((lambda *s: torch.randn(*s, dtype=torch.bfloat16) * 0.2)(B, S, D)),
            "shift_k": _w((lambda *s: torch.randn(*s, dtype=torch.bfloat16) * 0.2)(D, ks) * 0.5),
            "ssm_k": _w((lambda *s: torch.randn(*s, dtype=torch.bfloat16) * 0.4)(D, S) * (1.0 / S ** 0.5)),
            "ssm_D": _w((lambda *s: torch.randn(*s, dtype=torch.bfloat16) * 0.2)(D)),
        }
    _A_in = _A_setup()

    def _B_setup():
        B, S, D, F = 1, 2048, 448, 1792
        return {
            "x": _w((lambda *s: torch.randn(*s, dtype=torch.bfloat16) * 0.05)(B, S, D)),
            "w1": _w((lambda *s: torch.randn(*s, dtype=torch.bfloat16) * 0.2)(D, F) * (2.0 / D) ** 0.5),
            "w3": _w((lambda *s: torch.randn(*s, dtype=torch.bfloat16) * 0.2)(D, F) * (2.0 / D) ** 0.5),
            "w2": _w((lambda *s: torch.randn(*s, dtype=torch.bfloat16) * 0.2)(F, D) * (2.0 / F) ** 0.5),
        }
    _B_in = _B_setup()

    return {
        "A_q": _A_in["q"],
        "A_k": _A_in["k"],
        "A_v": _A_in["v"],
        "A_shift_k": _A_in["shift_k"],
        "A_ssm_k": _A_in["ssm_k"],
        "A_ssm_D": _A_in["ssm_D"],
        "B_x": _B_in["x"],
        "B_w1": _B_in["w1"],
        "B_w3": _B_in["w3"],
        "B_w2": _B_in["w2"],
    }

def reference(A_q, A_k, A_v, A_shift_k, A_ssm_k, A_ssm_D, B_x, B_w1, B_w3, B_w2):
    def _A_ref(q, k, v, shift_k, ssm_k, ssm_D):
        B, S, D = q.shape
        ks = shift_k.shape[-1]
        k_pad = _pad(k, ((0, 0), (ks - 1, 0), (0, 0)))
        k_shift = torch.zeros_like(k)
        for t in range(ks):
            k_shift = k_shift + k_pad[:, t:t + S, :] * shift_k[:, ks - 1 - t][None, None, :]
        kv = k_shift * v
        L = 2 * S
        kv_pad = _pad(kv, ((0, 0), (0, S), (0, 0)))
        kf_pad = _pad(ssm_k, ((0, 0), (0, S)))
        kv_f = (lambda x, axes=(-2,-1): torch.fft.rfft2(x.float(), dim=axes))(kv_pad[:, None, :, :], axes=(1, 2))
        kf_f = (lambda x, axes=(-2,-1): torch.fft.rfft2(x.float(), dim=axes))(kf_pad[:, None, :], axes=(1, 2))
        kf_f = (lambda x, *d: x.permute(*d))(kf_f, 1, 2, 0)
        y_f = kv_f * kf_f[None, :, :, :]
        y = (lambda x, s, axes=(-2,-1): torch.fft.irfft2(x, s=s, dim=axes).to(torch.bfloat16))(y_f, (1, L), axes=(1, 2))[:, 0, :S, :]
        y = y + kv * ssm_D[None, None, :]
        return q * y

    def _B_ref(x, w1, w3, w2):
        gate = torch.einsum("bsd,df->bsf", x, w1)
        up = torch.einsum("bsd,df->bsf", x, w3)
        h = _silu(gate) * up
        out = torch.einsum("bsf,fd->bsd", h, w2)
        return out

    x = A_q
    xn = _layernorm(x, axis=-1)
    return x + _A_ref(xn, A_k, A_v, A_shift_k, A_ssm_k, A_ssm_D) + _B_ref(xn, B_w1, B_w3, B_w2)
```

```asm
; @launch grid=(256,1,1) block=(512,1,1) lds=163840
.amdgcn_target "amdgcn-amd-amdhsa--gfx950"
.text
.globl parallel_sum__ssm_conv_h3__glu_gated_swiglu__prompt_kernel
.p2align 8
.type parallel_sum__ssm_conv_h3__glu_gated_swiglu__prompt_kernel,@function
parallel_sum__ssm_conv_h3__glu_gated_swiglu__prompt_kernel:
    s_cmp_ge_u32 s2, 256
    s_cbranch_scc1 L_end
    s_load_dwordx2 s[4:5], s[0:1], 0
    s_load_dwordx2 s[28:29], s[0:1], 56
    s_load_dwordx2 s[32:33], s[0:1], 64
    s_load_dwordx2 s[44:45], s[0:1], 96
    s_load_dwordx2 s[8:9], s[0:1], 8
    s_load_dwordx2 s[12:13], s[0:1], 16
    s_load_dwordx2 s[16:17], s[0:1], 24
    s_load_dwordx2 s[20:21], s[0:1], 32
    s_load_dwordx2 s[24:25], s[0:1], 40
    s_load_dwordx2 s[36:37], s[0:1], 72
    s_load_dwordx2 s[40:41], s[0:1], 80
    v_lshrrev_b32 v1, 6, v0
    s_and_b32 s52, s2, 7
    v_readfirstlane_b32 s55, v1
    s_lshr_b32 s56, s2, 3
    s_mov_b32 s6, 1835008
    s_mov_b32 s7, 0x20000
    s_mov_b32 s30, 1605632
    s_mov_b32 s31, 0x20000
    s_mov_b32 s34, 1605632
    s_mov_b32 s35, 0x20000
    s_mov_b32 s46, 16777216
    s_mov_b32 s47, 0x20000
    s_mov_b32 s10, 1835008
    s_mov_b32 s11, 0x20000
    s_mov_b32 s14, 1835008
    s_mov_b32 s15, 0x20000
    s_mov_b32 s18, 3584
    s_mov_b32 s19, 0x20000
    s_mov_b32 s22, 1835008
    s_mov_b32 s23, 0x20000
    s_mov_b32 s26, 896
    s_mov_b32 s27, 0x20000
    s_mov_b32 s38, 1605632
    s_mov_b32 s39, 0x20000
    s_mov_b32 s42, 1835008
    s_mov_b32 s43, 0x20000
    s_sub_u32 s54, s56, 4
    s_mul_i32 s53, s54, 37
    s_lshr_b32 s53, s53, 8
    s_mul_i32 s58, s53, 7
    s_sub_u32 s54, s54, s58
    s_and_b32 s48, s55, 3
    s_lshr_b32 s49, s52, 1
    s_lshl_b32 s49, s49, 2
    s_add_u32 s49, s49, s53
    s_and_b32 s50, s52, 1
    s_mul_i32 s50, s50, 7
    s_add_u32 s50, s50, s54
    s_lshl_b32 s51, s52, 2
    s_add_u32 s51, s51, s53
    v_and_b32 v1, 63, v0
    s_lshl_b32 s57, s48, 12
    s_cmp_lt_u32 s56, 4
    s_cbranch_scc1 L_spare
    s_cmp_lt_u32 s55, 4
    s_cbranch_scc1 L_mwave
    s_mul_i32 s60, s49, 114688
    s_mul_i32 s58, s48, 28672
    s_add_u32 s60, s60, s58
    s_lshl_b32 s61, s50, 8
    s_and_b32 s58, s48, 1
    s_mul_i32 s58, s58, 114688
    s_add_u32 s61, s61, s58
    v_lshrrev_b32 v6, 3, v1
    v_and_b32 v7, 7, v1
    v_lshrrev_b32 v8, 4, v1
    v_xor_b32 v9, v7, v8
    v_mul_u32_u24 v10, 896, v6
    v_lshl_add_u32 v16, v9, 4, v10
    v_xor_b32 v9, 4, v9
    v_lshl_add_u32 v17, v9, 4, v10
    v_add_u32 v17, 6144, v17
    v_add_u32 v18, 12288, v16
    v_add_u32 v19, 12288, v17
    v_and_b32 v9, 1, v8
    v_lshlrev_b32 v9, 2, v9
    v_xor_b32 v9, v7, v9
    v_mul_u32_u24 v11, 3584, v6
    v_lshl_add_u32 v20, v9, 4, v11
    v_add_u32 v21, 27648, v20
    v_add_u32 v22, 55296, v20
    v_add_u32 v23, 82944, v20
    s_waitcnt lgkmcnt(0)
    s_load_dword s78, s[44:45], 0
    s_cmp_ge_u32 s48, 2
    s_cselect_b32 s28, s32, s28
    s_cselect_b32 s29, s33, s29
    s_add_u32 m0, s57, 0
    s_add_u32 s58, s60, 0
    buffer_load_dwordx4 v16, s[4:7], s58 offen offset:0 lds
    buffer_load_dwordx4 v17, s[4:7], s58 offen offset:1024 lds
    buffer_load_dwordx4 v18, s[4:7], s58 offen offset:2048 lds
    buffer_load_dwordx4 v19, s[4:7], s58 offen offset:3072 lds
    s_add_u32 m0, s57, 16384
    s_add_u32 s58, s61, 0
    buffer_load_dwordx4 v20, s[28:31], s58 offen offset:0 lds
    buffer_load_dwordx4 v21, s[28:31], s58 offen offset:1024 lds
    buffer_load_dwordx4 v22, s[28:31], s58 offen offset:2048 lds
    buffer_load_dwordx4 v23, s[28:31], s58 offen offset:3072 lds
    s_add_u32 m0, s57, 32768
    s_add_u32 s58, s61, 128
    buffer_load_dwordx4 v20, s[28:31], s58 offen offset:0 lds
    buffer_load_dwordx4 v21, s[28:31], s58 offen offset:1024 lds
    buffer_load_dwordx4 v22, s[28:31], s58 offen offset:2048 lds
    buffer_load_dwordx4 v23, s[28:31], s58 offen offset:3072 lds
    v_lshl_add_u32 v64, v7, 4, v10
    v_add_u32 v65, 6144, v64
    s_mul_i32 s65, s51, 57344
    s_lshl_b32 s75, s54, 7
    s_add_u32 s76, s75, 57344
    s_add_u32 s65, s65, s75
    s_mul_i32 s58, s48, 14336
    s_add_u32 s65, s65, s58
    s_lshl_b32 s64, s48, 11
    s_add_u32 m0, s64, 49152
    s_nop 0
    buffer_load_dwordx4 v64, s[8:11], s65 offen offset:0 lds
    buffer_load_dwordx4 v65, s[8:11], s65 offen offset:1024 lds
    s_add_u32 m0, s64, 57344
    s_nop 0
    buffer_load_dwordx4 v64, s[12:15], s65 offen offset:0 lds
    buffer_load_dwordx4 v65, s[12:15], s65 offen offset:1024 lds
    s_add_u32 m0, s57, 114688
    s_add_u32 s58, s60, 128
    buffer_load_dwordx4 v16, s[4:7], s58 offen offset:0 lds
    buffer_load_dwordx4 v17, s[4:7], s58 offen offset:1024 lds
    buffer_load_dwordx4 v18, s[4:7], s58 offen offset:2048 lds
    buffer_load_dwordx4 v19, s[4:7], s58 offen offset:3072 lds
    s_waitcnt lgkmcnt(0)
    s_mul_i32 s77, s78, 0x9E3779B1
    s_add_u32 s77, s77, 0x7F4A7C15
    s_lshr_b32 s78, s77, 15
    s_xor_b32 s78, s78, s77
    s_and_b32 s78, s78, 0xBFFFBFFF
    s_mov_b32 s79, s78
    v_mov_b32 v15, s78
    s_waitcnt vmcnt(8)
    s_barrier
    s_add_u32 m0, s57, 131072
    s_add_u32 s58, s61, 229376
    buffer_load_dwordx4 v20, s[28:31], s58 offen offset:0 lds
    buffer_load_dwordx4 v21, s[28:31], s58 offen offset:1024 lds
    buffer_load_dwordx4 v22, s[28:31], s58 offen offset:2048 lds
    buffer_load_dwordx4 v23, s[28:31], s58 offen offset:3072 lds
    s_add_u32 m0, s57, 147456
    s_add_u32 s58, s61, 229504
    buffer_load_dwordx4 v20, s[28:31], s58 offen offset:0 lds
    buffer_load_dwordx4 v21, s[28:31], s58 offen offset:1024 lds
    buffer_load_dwordx4 v22, s[28:31], s58 offen offset:2048 lds
    buffer_load_dwordx4 v23, s[28:31], s58 offen offset:3072 lds
    s_lshl_b32 s58, s48, 9
    s_add_u32 s58, s58, 63488
    v_lshrrev_b32 v67, 1, v7
    v_lshlrev_b32 v67, 11, v67
    v_lshlrev_b32 v66, 5, v6
    v_sub_u32 v66, v66, v67
    v_and_b32 v67, 1, v7
    v_lshl_add_u32 v66, v67, 4, v66
    v_add_u32 v66, s58, v66
    v_mul_u32_u24 v68, 4224, v6
    v_lshl_add_u32 v68, v7, 4, v68
    s_lshl_b32 s72, s54, 2
    s_add_u32 s72, s72, s48
    s_mul_i32 s62, s72, 67584
    s_lshl_b32 s63, s51, 7
    s_sub_u32 s62, s62, s63
    s_add_u32 s62, s62, 200576
    s_add_u32 s63, s62, 33792
    s_lshl_b32 s64, s72, 7
    s_lshl_b32 s58, s51, 2
    s_add_u32 s64, s64, s58
    s_add_u32 s64, s64, 4096
    s_lshl_b32 s3, s53, 1
    s_add_u32 s3, s3, s54
    s_cmp_ge_u32 s3, 7
    s_cselect_b32 s58, 7, 0
    s_sub_u32 s3, s3, s58
    v_lshlrev_b32 v2, 4, v1
    s_lshl_b32 s58, s48, 2
    s_add_u32 s58, s58, 151040
    v_mov_b32 v3, s58
    v_and_b32 v0, 3, v1
    v_lshlrev_b32 v0, 2, v0
    v_add_u32 v0, 151040, v0
    v_mov_b32 v69, v7
    v_lshrrev_b32 v8, 3, v1
    v_and_b32 v9, 7, v1
    v_bfe_u32 v10, v1, 4, 1
    v_lshlrev_b32 v10, 2, v10
    v_xor_b32 v9, v9, v10
    v_mul_u32_u24 v8, 896, v8
    v_lshl_add_u32 v4, v9, 4, v8
    v_add_u32 v5, 6144, v4
    v_add_u32 v6, 12288, v4
    v_add_u32 v7, 18432, v4
    v_bfe_u32 v8, v1, 2, 2
    v_lshrrev_b32 v9, 5, v1
    v_lshl_add_u32 v10, v9, 2, v8
    v_lshlrev_b32 v10, 7, v10
    v_bfe_u32 v9, v1, 4, 1
    v_lshl_add_u32 v10, v9, 5, v10
    v_and_b32 v9, 3, v1
    v_lshl_add_u32 v10, v9, 3, v10
    v_add_u32 v10, s57, v10
    v_lshrrev_b32 v8, 1, v8
    v_lshl_add_u32 v40, v8, 6, v10
    v_xor_b32 v8, 1, v8
    v_lshl_add_u32 v41, v8, 6, v10
    v_add_u32 v42, 0x10000, v40
    v_add_u32 v43, 0x10000, v41
    s_mul_i32 s74, s52, 28
    s_add_u32 s74, s74, s56
    s_sub_u32 s74, s74, 4
    s_and_b32 s65, s48, 1
    s_lshr_b32 s66, s48, 1
    s_lshl_b32 s67, s74, 1
    s_add_u32 s67, s67, s65
    s_mul_i32 s71, s65, 18176
    s_add_u32 s71, s71, 114688
    s_lshr_b32 s68, s74, 3
    s_lshl_b32 s68, s68, 7
    s_add_u32 s68, s68, 4096
    v_and_b32 v33, 31, v1
    v_lshlrev_b32 v33, 2, v33
    s_lshl_b32 s69, s67, 12
    s_lshl_b32 s58, s66, 2
    s_add_u32 s69, s69, s58
    s_mul_i32 s70, s67, 4224
    s_add_u32 s70, s70, 196610
    s_lshl_b32 s58, s66, 1
    s_sub_u32 s70, s70, s58
    s_mul_i32 s72, s66, 4480
    s_add_u32 s72, s72, s71
    s_add_u32 s72, s72, 256
    s_mul_i32 s73, s66, 4576
    s_add_u32 s73, s73, s71
    s_add_u32 s73, s73, 8960
    v_mov_b32 v28, 0
    v_mov_b32 v29, 0
    v_mov_b32 v30, 0
    v_mov_b32 v31, 0
    s_sub_u32 s58, s72, 256
    v_add_u32 v27, s58, v2
    s_add_u32 s58, s73, 3840
    v_add_u32 v32, s58, v2
    v_cmp_gt_u32 vcc, 16, v1
    s_nop 1
    v_cndmask_b32 v27, v32, v27, vcc
    s_add_u32 m0, s57, 65536
    s_add_u32 s58, s60, 256
    buffer_load_dwordx4 v16, s[4:7], s58 offen offset:0 lds
    buffer_load_dwordx4 v17, s[4:7], s58 offen offset:1024 lds
    buffer_load_dwordx4 v18, s[4:7], s58 offen offset:2048 lds
    buffer_load_dwordx4 v19, s[4:7], s58 offen offset:3072 lds
    s_add_u32 m0, s57, 81920
    s_add_u32 s58, s61, 458752
    buffer_load_dwordx4 v20, s[28:31], s58 offen offset:0 lds
    buffer_load_dwordx4 v21, s[28:31], s58 offen offset:1024 lds
    buffer_load_dwordx4 v22, s[28:31], s58 offen offset:2048 lds
    buffer_load_dwordx4 v23, s[28:31], s58 offen offset:3072 lds
    s_waitcnt vmcnt(8)
    s_barrier
    s_add_u32 m0, s57, 98304
    s_add_u32 s58, s61, 458880
    buffer_load_dwordx4 v20, s[28:31], s58 offen offset:0 lds
    buffer_load_dwordx4 v21, s[28:31], s58 offen offset:1024 lds
    buffer_load_dwordx4 v22, s[28:31], s58 offen offset:2048 lds
    buffer_load_dwordx4 v23, s[28:31], s58 offen offset:3072 lds
    s_add_u32 m0, s57, 0
    s_add_u32 s58, s60, 384
    buffer_load_dwordx4 v16, s[4:7], s58 offen offset:0 lds
    buffer_load_dwordx4 v17, s[4:7], s58 offen offset:1024 lds
    buffer_load_dwordx4 v18, s[4:7], s58 offen offset:2048 lds
    buffer_load_dwordx4 v19, s[4:7], s58 offen offset:3072 lds
    s_add_u32 m0, s57, 16384
    s_add_u32 s58, s61, 688128
    buffer_load_dwordx4 v20, s[28:31], s58 offen offset:0 lds
    buffer_load_dwordx4 v21, s[28:31], s58 offen offset:1024 lds
    buffer_load_dwordx4 v22, s[28:31], s58 offen offset:2048 lds
    buffer_load_dwordx4 v23, s[28:31], s58 offen offset:3072 lds
    s_add_u32 m0, s57, 32768
    s_add_u32 s58, s61, 688256
    buffer_load_dwordx4 v20, s[28:31], s58 offen offset:0 lds
    buffer_load_dwordx4 v21, s[28:31], s58 offen offset:1024 lds
    buffer_load_dwordx4 v22, s[28:31], s58 offen offset:2048 lds
    buffer_load_dwordx4 v23, s[28:31], s58 offen offset:3072 lds
    s_waitcnt vmcnt(12)
    s_barrier
    ds_read_b128 v[72:75], v66 offset:0
    ds_read_b128 v[76:79], v66 offset:256
    s_waitcnt lgkmcnt(0)
    buffer_store_dwordx4 v[72:75], v68, s[44:47], s62 offen sc1
    buffer_store_dwordx4 v[76:79], v68, s[44:47], s63 offen sc1
    s_cmp_lg_u32 s51, 0
    s_cbranch_scc1 L_nopad
    v_cmp_eq_u32 vcc, 7, v69
    s_and_saveexec_b64 s[58:59], vcc
    buffer_store_dwordx4 v[28:31], v68, s[44:47], s62 offen offset:16 sc1
    buffer_store_dwordx4 v[28:31], v68, s[44:47], s63 offen offset:16 sc1
    s_mov_b64 exec, s[58:59]
L_nopad:
    s_add_u32 m0, s57, 114688
    s_add_u32 s58, s60, 512
    buffer_load_dwordx4 v16, s[4:7], s58 offen offset:0 lds
    buffer_load_dwordx4 v17, s[4:7], s58 offen offset:1024 lds
    buffer_load_dwordx4 v18, s[4:7], s58 offen offset:2048 lds
    buffer_load_dwordx4 v19, s[4:7], s58 offen offset:3072 lds
    s_add_u32 m0, s57, 131072
    s_add_u32 s58, s61, 917504
    buffer_load_dwordx4 v20, s[28:31], s58 offen offset:0 lds
    buffer_load_dwordx4 v21, s[28:31], s58 offen offset:1024 lds
    buffer_load_dwordx4 v22, s[28:31], s58 offen offset:2048 lds
    buffer_load_dwordx4 v23, s[28:31], s58 offen offset:3072 lds
    s_add_u32 m0, s57, 147456
    s_add_u32 s58, s61, 917632
    buffer_load_dwordx4 v20, s[28:31], s58 offen offset:0 lds
    buffer_load_dwordx4 v21, s[28:31], s58 offen offset:1024 lds
    buffer_load_dwordx4 v22, s[28:31], s58 offen offset:2048 lds
    buffer_load_dwordx4 v23, s[28:31], s58 offen offset:3072 lds
    s_waitcnt vmcnt(14)
    s_barrier
    s_waitcnt vmcnt(12)
    v_mov_b32 v24, 0
    v_mov_b32 v25, s78
    s_mov_b64 exec, 1
    buffer_store_dword v25, v24, s[44:47], s64 offen sc1
    s_mov_b64 exec, -1
    v_mov_b32 v24, 0
    s_lshl_b32 s58, s67, 1
    buffer_load_ushort v25, v24, s[24:27], s58 offen
    s_lshl_b32 s58, s67, 12
    buffer_load_dword v26, v24, s[20:23], s58 offen
    s_add_u32 m0, s57, 65536
    s_add_u32 s58, s60, 640
    buffer_load_dwordx4 v16, s[4:7], s58 offen offset:0 lds
    buffer_load_dwordx4 v17, s[4:7], s58 offen offset:1024 lds
    buffer_load_dwordx4 v18, s[4:7], s58 offen offset:2048 lds
    buffer_load_dwordx4 v19, s[4:7], s58 offen offset:3072 lds
    s_add_u32 m0, s57, 81920
    s_add_u32 s58, s61, 1146880
    buffer_load_dwordx4 v20, s[28:31], s58 offen offset:0 lds
    buffer_load_dwordx4 v21, s[28:31], s58 offen offset:1024 lds
    buffer_load_dwordx4 v22, s[28:31], s58 offen offset:2048 lds
    buffer_load_dwordx4 v23, s[28:31], s58 offen offset:3072 lds
    s_waitcnt vmcnt(11)
    s_barrier
    s_lshl_b32 s58, s50, 11
    s_and_b32 s59, s48, 1
    s_lshl_b32 s59, s59, 10
    s_add_u32 s58, s58, s59
    s_lshr_b32 s59, s48, 1
    s_mul_i32 s59, s59, 28672
    s_add_u32 s58, s58, s59
    s_add_u32 s58, s58, 98304
    s_lshl_b32 s59, s48, 10
    s_add_u32 m0, s59, 49152
    s_nop 0
    buffer_load_dwordx4 v2, s[44:47], s58 offen sc1 lds
    s_lshl_b32 s58, s49, 11
    s_and_b32 s59, s48, 1
    s_lshl_b32 s59, s59, 10
    s_add_u32 s58, s58, s59
    s_add_u32 s58, s58, 65536
    s_add_u32 m0, s59, 53248
    s_nop 0
    buffer_load_dwordx4 v2, s[44:47], s58 offen sc1 lds
    s_add_u32 m0, s57, 98304
    s_add_u32 s58, s61, 1147008
    buffer_load_dwordx4 v20, s[28:31], s58 offen offset:0 lds
    buffer_load_dwordx4 v21, s[28:31], s58 offen offset:1024 lds
    buffer_load_dwordx4 v22, s[28:31], s58 offen offset:2048 lds
    buffer_load_dwordx4 v23, s[28:31], s58 offen offset:3072 lds
    s_add_u32 m0, s57, 0
    s_add_u32 s58, s60, 768
    buffer_load_dwordx4 v16, s[4:7], s58 offen offset:0 lds
    buffer_load_dwordx4 v17, s[4:7], s58 offen offset:1024 lds
    buffer_load_dwordx4 v18, s[4:7], s58 offen offset:2048 lds
    buffer_load_dwordx4 v19, s[4:7], s58 offen offset:3072 lds
    s_add_u32 m0, s57, 16384
    s_add_u32 s58, s61, 1376256
    buffer_load_dwordx4 v20, s[28:31], s58 offen offset:0 lds
    buffer_load_dwordx4 v21, s[28:31], s58 offen offset:1024 lds
    buffer_load_dwordx4 v22, s[28:31], s58 offen offset:2048 lds
    buffer_load_dwordx4 v23, s[28:31], s58 offen offset:3072 lds
    s_waitcnt vmcnt(8)
    s_barrier
    s_add_u32 m0, s57, 32768
    s_add_u32 s58, s61, 1376384
    buffer_load_dwordx4 v20, s[28:31], s58 offen offset:0 lds
    buffer_load_dwordx4 v21, s[28:31], s58 offen offset:1024 lds
    buffer_load_dwordx4 v22, s[28:31], s58 offen offset:2048 lds
    buffer_load_dwordx4 v23, s[28:31], s58 offen offset:3072 lds
    s_mov_b32 m0, s72
    s_nop 0
    buffer_load_dwordx4 v2, s[20:23], s69 offen offset:0 lds
    buffer_load_dwordx4 v2, s[20:23], s69 offen offset:1024 lds
    buffer_load_dwordx4 v2, s[20:23], s69 offen offset:2048 lds
    buffer_load_dwordx4 v2, s[20:23], s69 offen offset:3072 lds
    buffer_load_dword v35, v33, s[44:47], s68 offen sc1
    s_waitcnt vmcnt(0)
    v_cmp_ne_u32 vcc, s78, v35
    s_cbranch_vccz L_polled1
    s_mov_b32 s58, 0
L_poll1:
    buffer_load_dword v35, v33, s[44:47], s68 offen sc1
    s_waitcnt vmcnt(0)
    v_cmp_ne_u32 vcc, s78, v35
    s_cbranch_vccz L_polled1
    s_add_u32 s58, s58, 1
    s_cmp_lt_u32 s58, 0x40000
    s_cbranch_scc0 L_polled1
    s_sleep 12
    s_branch L_poll1
L_polled1:
    s_mov_b32 m0, s73
    s_nop 0
    buffer_load_dwordx4 v2, s[44:47], s70 offen offset:0 sc1 lds
    buffer_load_dwordx4 v2, s[44:47], s70 offen offset:1024 sc1 lds
    buffer_load_dwordx4 v2, s[44:47], s70 offen offset:2048 sc1 lds
    buffer_load_dwordx4 v2, s[44:47], s70 offen offset:3072 sc1 lds
    v_cmp_gt_u32 vcc, 44, v1
    s_and_saveexec_b64 s[58:59], vcc
    ds_write_b128 v27, v[28:31]
    s_mov_b64 exec, s[58:59]
    s_lshl_b32 s58, s66, 2
    s_sub_u32 s58, s72, s58
    s_sub_u32 s58, s58, 192
    v_mov_b32 v27, s58
    s_waitcnt vmcnt(9)
    ds_write_b32 v27, v25
    s_cmp_eq_u32 s66, 0
    s_cbranch_scc1 L_cv_nofix
    ds_write_b32 v27, v26 offset:192
L_cv_nofix:
    s_barrier
    s_add_u32 s58, s3, 0
    s_cmp_ge_u32 s58, 7
    s_cselect_b32 s59, 7, 0
    s_sub_u32 s58, s58, s59
    s_mul_i32 s59, s48, 7
    s_add_u32 s58, s58, s59
    s_lshr_b32 s59, s58, 1
    s_mul_i32 s59, s59, 114688
    s_and_b32 s58, s58, 1
    s_mul_i32 s58, s58, 28672
    s_add_u32 s58, s58, s59
    s_add_u32 m0, s57, 49152
    s_add_u32 s58, s58, s76
    buffer_load_dwordx4 v4, s[36:39], s58 offen offset:0 lds
    buffer_load_dwordx4 v5, s[36:39], s58 offen offset:1024 lds
    buffer_load_dwordx4 v6, s[36:39], s58 offen offset:2048 lds
    buffer_load_dwordx4 v7, s[36:39], s58 offen offset:3072 lds
    s_add_u32 s58, s3, 1
    s_cmp_ge_u32 s58, 7
    s_cselect_b32 s59, 7, 0
    s_sub_u32 s58, s58, s59
    s_mul_i32 s59, s48, 7
    s_add_u32 s58, s58, s59
    s_lshr_b32 s59, s58, 1
    s_mul_i32 s59, s59, 114688
    s_and_b32 s58, s58, 1
    s_mul_i32 s58, s58, 28672
    s_add_u32 s58, s58, s59
    s_add_u32 m0, s57, 65536
    s_add_u32 s58, s58, s76
    buffer_load_dwordx4 v4, s[36:39], s58 offen offset:0 lds
    buffer_load_dwordx4 v5, s[36:39], s58 offen offset:1024 lds
    buffer_load_dwordx4 v6, s[36:39], s58 offen offset:2048 lds
    buffer_load_dwordx4 v7, s[36:39], s58 offen offset:3072 lds
    s_add_u32 s58, s3, 2
    s_cmp_ge_u32 s58, 7
    s_cselect_b32 s59, 7, 0
    s_sub_u32 s58, s58, s59
    s_mul_i32 s59, s48, 7
    s_add_u32 s58, s58, s59
    s_lshr_b32 s59, s58, 1
    s_mul_i32 s59, s59, 114688
    s_and_b32 s58, s58, 1
    s_mul_i32 s58, s58, 28672
    s_add_u32 s58, s58, s59
    s_add_u32 m0, s57, 81920
    s_add_u32 s58, s58, s76
    buffer_load_dwordx4 v4, s[36:39], s58 offen offset:0 lds
    buffer_load_dwordx4 v5, s[36:39], s58 offen offset:1024 lds
    buffer_load_dwordx4 v6, s[36:39], s58 offen offset:2048 lds
    buffer_load_dwordx4 v7, s[36:39], s58 offen offset:3072 lds
    s_add_u32 s58, s3, 3
    s_cmp_ge_u32 s58, 7
    s_cselect_b32 s59, 7, 0
    s_sub_u32 s58, s58, s59
    s_mul_i32 s59, s48, 7
    s_add_u32 s58, s58, s59
    s_lshr_b32 s59, s58, 1
    s_mul_i32 s59, s59, 114688
    s_and_b32 s58, s58, 1
    s_mul_i32 s58, s58, 28672
    s_add_u32 s58, s58, s59
    s_add_u32 m0, s57, 98304
    s_add_u32 s58, s58, s76
    buffer_load_dwordx4 v4, s[36:39], s58 offen offset:0 lds
    buffer_load_dwordx4 v5, s[36:39], s58 offen offset:1024 lds
    buffer_load_dwordx4 v6, s[36:39], s58 offen offset:2048 lds
    buffer_load_dwordx4 v7, s[36:39], s58 offen offset:3072 lds
    s_waitcnt vmcnt(12)
    ds_read_b64_tr_b16 v[144:145], v40 offset:49152
    ds_read_b64_tr_b16 v[146:147], v40 offset:50176
    ds_read_b64_tr_b16 v[148:149], v41 offset:49152
    ds_read_b64_tr_b16 v[150:151], v41 offset:50176
    ds_read_b64_tr_b16 v[152:153], v40 offset:51200
    ds_read_b64_tr_b16 v[154:155], v40 offset:52224
    ds_read_b64_tr_b16 v[156:157], v41 offset:51200
    ds_read_b64_tr_b16 v[158:159], v41 offset:52224
    s_waitcnt lgkmcnt(0)
    s_add_u32 s58, s3, 4
    s_cmp_ge_u32 s58, 7
    s_cselect_b32 s59, 7, 0
    s_sub_u32 s58, s58, s59
    s_mul_i32 s59, s48, 7
    s_add_u32 s58, s58, s59
    s_lshr_b32 s59, s58, 1
    s_mul_i32 s59, s59, 114688
    s_and_b32 s58, s58, 1
    s_mul_i32 s58, s58, 28672
    s_add_u32 s58, s58, s59
    s_add_u32 m0, s57, 49152
    s_add_u32 s58, s58, s76
    buffer_load_dwordx4 v4, s[36:39], s58 offen offset:0 lds
    buffer_load_dwordx4 v5, s[36:39], s58 offen offset:1024 lds
    buffer_load_dwordx4 v6, s[36:39], s58 offen offset:2048 lds
    buffer_load_dwordx4 v7, s[36:39], s58 offen offset:3072 lds
    s_waitcnt vmcnt(12)
    ds_read_b64_tr_b16 v[160:161], v42 offset:0
    ds_read_b64_tr_b16 v[162:163], v42 offset:1024
    ds_read_b64_tr_b16 v[164:165], v43 offset:0
    ds_read_b64_tr_b16 v[166:167], v43 offset:1024
    ds_read_b64_tr_b16 v[168:169], v42 offset:2048
    ds_read_b64_tr_b16 v[170:171], v42 offset:3072
    ds_read_b64_tr_b16 v[172:173], v43 offset:2048
    ds_read_b64_tr_b16 v[174:175], v43 offset:3072
    s_waitcnt lgkmcnt(0)
    ds_write_b32 v3, v15 offset:48
    s_add_u32 s58, s3, 5
    s_cmp_ge_u32 s58, 7
    s_cselect_b32 s59, 7, 0
    s_sub_u32 s58, s58, s59
    s_mul_i32 s59, s48, 7
    s_add_u32 s58, s58, s59
    s_lshr_b32 s59, s58, 1
    s_mul_i32 s59, s59, 114688
    s_and_b32 s58, s58, 1
    s_mul_i32 s58, s58, 28672
    s_add_u32 s58, s58, s59
    s_add_u32 m0, s57, 65536
    s_add_u32 s58, s58, s76
    buffer_load_dwordx4 v4, s[36:39], s58 offen offset:0 lds
    buffer_load_dwordx4 v5, s[36:39], s58 offen offset:1024 lds
    buffer_load_dwordx4 v6, s[36:39], s58 offen offset:2048 lds
    buffer_load_dwordx4 v7, s[36:39], s58 offen offset:3072 lds
    s_waitcnt vmcnt(12)
    ds_read_b64_tr_b16 v[176:177], v42 offset:16384
    ds_read_b64_tr_b16 v[178:179], v42 offset:17408
    ds_read_b64_tr_b16 v[180:181], v43 offset:16384
    ds_read_b64_tr_b16 v[182:183], v43 offset:17408
    ds_read_b64_tr_b16 v[184:185], v42 offset:18432
    ds_read_b64_tr_b16 v[186:187], v42 offset:19456
    ds_read_b64_tr_b16 v[188:189], v43 offset:18432
    ds_read_b64_tr_b16 v[190:191], v43 offset:19456
    s_waitcnt lgkmcnt(0)
    s_add_u32 s58, s3, 6
    s_cmp_ge_u32 s58, 7
    s_cselect_b32 s59, 7, 0
    s_sub_u32 s58, s58, s59
    s_mul_i32 s59, s48, 7
    s_add_u32 s58, s58, s59
    s_lshr_b32 s59, s58, 1
    s_mul_i32 s59, s59, 114688
    s_and_b32 s58, s58, 1
    s_mul_i32 s58, s58, 28672
    s_add_u32 s58, s58, s59
    s_add_u32 m0, s57, 81920
    s_add_u32 s58, s58, s76
    buffer_load_dwordx4 v4, s[36:39], s58 offen offset:0 lds
    buffer_load_dwordx4 v5, s[36:39], s58 offen offset:1024 lds
    buffer_load_dwordx4 v6, s[36:39], s58 offen offset:2048 lds
    buffer_load_dwordx4 v7, s[36:39], s58 offen offset:3072 lds
    s_waitcnt vmcnt(12)
    ds_read_b64_tr_b16 v[192:193], v42 offset:32768
    ds_read_b64_tr_b16 v[194:195], v42 offset:33792
    ds_read_b64_tr_b16 v[196:197], v43 offset:32768
    ds_read_b64_tr_b16 v[198:199], v43 offset:33792
    ds_read_b64_tr_b16 v[200:201], v42 offset:34816
    ds_read_b64_tr_b16 v[202:203], v42 offset:35840
    ds_read_b64_tr_b16 v[204:205], v43 offset:34816
    ds_read_b64_tr_b16 v[206:207], v43 offset:35840
    s_waitcnt lgkmcnt(0)
    s_add_u32 s58, s3, 0
    s_cmp_ge_u32 s58, 7
    s_cselect_b32 s59, 7, 0
    s_sub_u32 s58, s58, s59
    s_mul_i32 s59, s48, 7
    s_add_u32 s58, s58, s59
    s_lshr_b32 s59, s58, 1
    s_mul_i32 s59, s59, 114688
    s_and_b32 s58, s58, 1
    s_mul_i32 s58, s58, 28672
    s_add_u32 s58, s58, s59
    s_add_u32 m0, s57, 98304
    s_add_u32 s58, s58, s75
    buffer_load_dwordx4 v4, s[36:39], s58 offen offset:0 lds
    buffer_load_dwordx4 v5, s[36:39], s58 offen offset:1024 lds
    buffer_load_dwordx4 v6, s[36:39], s58 offen offset:2048 lds
    buffer_load_dwordx4 v7, s[36:39], s58 offen offset:3072 lds
    s_mov_b32 s58, 0
L_lw2:
    ds_read_b32 v34, v0 offset:0
    s_waitcnt lgkmcnt(0)
    v_cmp_ne_u32 vcc, s78, v34
    s_cbranch_vccz L_lwd2
    s_add_u32 s58, s58, 1
    s_cmp_lt_u32 s58, 0x400000
    s_cbranch_scc0 L_lwd2
    s_sleep 1
    s_branch L_lw2
L_lwd2:
    s_add_u32 s58, s3, 1
    s_cmp_ge_u32 s58, 7
    s_cselect_b32 s59, 7, 0
    s_sub_u32 s58, s58, s59
    s_mul_i32 s59, s48, 7
    s_add_u32 s58, s58, s59
    s_lshr_b32 s59, s58, 1
    s_mul_i32 s59, s59, 114688
    s_and_b32 s58, s58, 1
    s_mul_i32 s58, s58, 28672
    s_add_u32 s58, s58, s59
    s_add_u32 m0, s57, 0
    s_add_u32 s58, s58, s75
    buffer_load_dwordx4 v4, s[36:39], s58 offen offset:0 lds
    buffer_load_dwordx4 v5, s[36:39], s58 offen offset:1024 lds
    buffer_load_dwordx4 v6, s[36:39], s58 offen offset:2048 lds
    buffer_load_dwordx4 v7, s[36:39], s58 offen offset:3072 lds
    s_waitcnt vmcnt(16)
    ds_read_b64_tr_b16 v[208:209], v40 offset:49152
    ds_read_b64_tr_b16 v[210:211], v40 offset:50176
    ds_read_b64_tr_b16 v[212:213], v41 offset:49152
    ds_read_b64_tr_b16 v[214:215], v41 offset:50176
    ds_read_b64_tr_b16 v[216:217], v40 offset:51200
    ds_read_b64_tr_b16 v[218:219], v40 offset:52224
    ds_read_b64_tr_b16 v[220:221], v41 offset:51200
    ds_read_b64_tr_b16 v[222:223], v41 offset:52224
    s_waitcnt lgkmcnt(0)
    s_add_u32 s58, s3, 2
    s_cmp_ge_u32 s58, 7
    s_cselect_b32 s59, 7, 0
    s_sub_u32 s58, s58, s59
    s_mul_i32 s59, s48, 7
    s_add_u32 s58, s58, s59
    s_lshr_b32 s59, s58, 1
    s_mul_i32 s59, s59, 114688
    s_and_b32 s58, s58, 1
    s_mul_i32 s58, s58, 28672
    s_add_u32 s58, s58, s59
    s_add_u32 m0, s57, 16384
    s_add_u32 s58, s58, s75
    buffer_load_dwordx4 v4, s[36:39], s58 offen offset:0 lds
    buffer_load_dwordx4 v5, s[36:39], s58 offen offset:1024 lds
    buffer_load_dwordx4 v6, s[36:39], s58 offen offset:2048 lds
    buffer_load_dwordx4 v7, s[36:39], s58 offen offset:3072 lds
    s_waitcnt vmcnt(16)
    ds_read_b64_tr_b16 v[224:225], v42 offset:0
    ds_read_b64_tr_b16 v[226:227], v42 offset:1024
    ds_read_b64_tr_b16 v[228:229], v43 offset:0
    ds_read_b64_tr_b16 v[230:231], v43 offset:1024
    ds_read_b64_tr_b16 v[232:233], v42 offset:2048
    ds_read_b64_tr_b16 v[234:235], v42 offset:3072
    ds_read_b64_tr_b16 v[236:237], v43 offset:2048
    ds_read_b64_tr_b16 v[238:239], v43 offset:3072
    s_waitcnt lgkmcnt(0)
    s_add_u32 s58, s3, 3
    s_cmp_ge_u32 s58, 7
    s_cselect_b32 s59, 7, 0
    s_sub_u32 s58, s58, s59
    s_mul_i32 s59, s48, 7
    s_add_u32 s58, s58, s59
    s_lshr_b32 s59, s58, 1
    s_mul_i32 s59, s59, 114688
    s_and_b32 s58, s58, 1
    s_mul_i32 s58, s58, 28672
    s_add_u32 s58, s58, s59
    s_add_u32 m0, s57, 32768
    s_add_u32 s58, s58, s75
    buffer_load_dwordx4 v4, s[36:39], s58 offen offset:0 lds
    buffer_load_dwordx4 v5, s[36:39], s58 offen offset:1024 lds
    buffer_load_dwordx4 v6, s[36:39], s58 offen offset:2048 lds
    buffer_load_dwordx4 v7, s[36:39], s58 offen offset:3072 lds
    s_waitcnt vmcnt(16)
    ds_read_b64_tr_b16 v[240:241], v42 offset:16384
    ds_read_b64_tr_b16 v[242:243], v42 offset:17408
    ds_read_b64_tr_b16 v[244:245], v43 offset:16384
    ds_read_b64_tr_b16 v[246:247], v43 offset:17408
    ds_read_b64_tr_b16 v[248:249], v42 offset:18432
    ds_read_b64_tr_b16 v[250:251], v42 offset:19456
    ds_read_b64_tr_b16 v[252:253], v43 offset:18432
    ds_read_b64_tr_b16 v[254:255], v43 offset:19456
    s_waitcnt lgkmcnt(0)
    s_add_u32 s58, s3, 4
    s_cmp_ge_u32 s58, 7
    s_cselect_b32 s59, 7, 0
    s_sub_u32 s58, s58, s59
    s_mul_i32 s59, s48, 7
    s_add_u32 s58, s58, s59
    s_lshr_b32 s59, s58, 1
    s_mul_i32 s59, s59, 114688
    s_and_b32 s58, s58, 1
    s_mul_i32 s58, s58, 28672
    s_add_u32 s58, s58, s59
    s_add_u32 m0, s57, 49152
    s_add_u32 s58, s58, s75
    buffer_load_dwordx4 v4, s[36:39], s58 offen offset:0 lds
    buffer_load_dwordx4 v5, s[36:39], s58 offen offset:1024 lds
    buffer_load_dwordx4 v6, s[36:39], s58 offen offset:2048 lds
    buffer_load_dwordx4 v7, s[36:39], s58 offen offset:3072 lds
    s_add_u32 s58, s3, 5
    s_cmp_ge_u32 s58, 7
    s_cselect_b32 s59, 7, 0
    s_sub_u32 s58, s58, s59
    s_mul_i32 s59, s48, 7
    s_add_u32 s58, s58, s59
    s_lshr_b32 s59, s58, 1
    s_mul_i32 s59, s59, 114688
    s_and_b32 s58, s58, 1
    s_mul_i32 s58, s58, 28672
    s_add_u32 s58, s58, s59
    s_add_u32 m0, s57, 65536
    s_add_u32 s58, s58, s75
    buffer_load_dwordx4 v4, s[36:39], s58 offen offset:0 lds
    buffer_load_dwordx4 v5, s[36:39], s58 offen offset:1024 lds
    buffer_load_dwordx4 v6, s[36:39], s58 offen offset:2048 lds
    buffer_load_dwordx4 v7, s[36:39], s58 offen offset:3072 lds
    s_add_u32 s58, s3, 6
    s_cmp_ge_u32 s58, 7
    s_cselect_b32 s59, 7, 0
    s_sub_u32 s58, s58, s59
    s_mul_i32 s59, s48, 7
    s_add_u32 s58, s58, s59
    s_lshr_b32 s59, s58, 1
    s_mul_i32 s59, s59, 114688
    s_and_b32 s58, s58, 1
    s_mul_i32 s58, s58, 28672
    s_add_u32 s58, s58, s59
    s_add_u32 m0, s57, 81920
    s_add_u32 s58, s58, s75
    buffer_load_dwordx4 v4, s[36:39], s58 offen offset:0 lds
    buffer_load_dwordx4 v5, s[36:39], s58 offen offset:1024 lds
    buffer_load_dwordx4 v6, s[36:39], s58 offen offset:2048 lds
    buffer_load_dwordx4 v7, s[36:39], s58 offen offset:3072 lds
    s_mul_i32 s62, s51, 114688
    s_add_u32 s62, s62, 7864320
    s_lshl_b32 s64, s51, 7
    s_lshl_b32 s58, s48, 5
    s_add_u32 s64, s64, s58
    s_add_u32 s64, s64, 20480
    s_setprio 3
    s_mov_b32 s58, 0
L_sp3:
    s_load_dwordx8 s[8:15], s[44:45], s64 glc
    s_waitcnt lgkmcnt(0)
    s_mov_b32 s15, s78
    s_xor_b64 s[8:9], s[8:9], s[78:79]
    s_xor_b64 s[10:11], s[10:11], s[78:79]
    s_xor_b64 s[12:13], s[12:13], s[78:79]
    s_xor_b64 s[14:15], s[14:15], s[78:79]
    s_or_b64 s[8:9], s[8:9], s[10:11]
    s_or_b64 s[12:13], s[12:13], s[14:15]
    s_or_b64 s[8:9], s[8:9], s[12:13]
    s_cbranch_scc0 L_spd3
    s_add_u32 s58, s58, 1
    s_cmp_lt_u32 s58, 0x40000
    s_sleep 8
    s_cbranch_scc1 L_sp3
L_spd3:
    s_add_u32 s58, s3, 0
    s_cmp_ge_u32 s58, 7
    s_cselect_b32 s59, 7, 0
    s_sub_u32 s58, s58, s59
    s_mul_i32 s59, s48, 7
    s_add_u32 s58, s58, s59
    s_lshl_b32 s63, s58, 11
    s_add_u32 s63, s63, s62
    s_add_u32 s61, s63, 57344
    buffer_load_dwordx4 v[16:19], v2, s[44:47], s63 offen offset:0 sc1
    buffer_load_dwordx4 v[20:23], v2, s[44:47], s61 offen offset:0 sc1
    buffer_load_dwordx4 v[24:27], v2, s[44:47], s63 offen offset:1024 sc1
    buffer_load_dwordx4 v[28:31], v2, s[44:47], s61 offen offset:1024 sc1
    s_add_u32 s58, s3, 1
    s_cmp_ge_u32 s58, 7
    s_cselect_b32 s59, 7, 0
    s_sub_u32 s58, s58, s59
    s_mul_i32 s59, s48, 7
    s_add_u32 s58, s58, s59
    s_lshl_b32 s63, s58, 11
    s_add_u32 s63, s63, s62
    s_add_u32 s61, s63, 57344
    buffer_load_dwordx4 v[32:35], v2, s[44:47], s63 offen offset:0 sc1
    buffer_load_dwordx4 v[36:39], v2, s[44:47], s61 offen offset:0 sc1
    buffer_load_dwordx4 v[40:43], v2, s[44:47], s63 offen offset:1024 sc1
    buffer_load_dwordx4 v[44:47], v2, s[44:47], s61 offen offset:1024 sc1
    s_add_u32 s58, s3, 2
    s_cmp_ge_u32 s58, 7
    s_cselect_b32 s59, 7, 0
    s_sub_u32 s58, s58, s59
    s_mul_i32 s59, s48, 7
    s_add_u32 s58, s58, s59
    s_lshl_b32 s63, s58, 11
    s_add_u32 s63, s63, s62
    s_add_u32 s61, s63, 57344
    buffer_load_dwordx4 v[48:51], v2, s[44:47], s63 offen offset:0 sc1
    buffer_load_dwordx4 v[52:55], v2, s[44:47], s61 offen offset:0 sc1
    buffer_load_dwordx4 v[56:59], v2, s[44:47], s63 offen offset:1024 sc1
    buffer_load_dwordx4 v[60:63], v2, s[44:47], s61 offen offset:1024 sc1
    s_add_u32 s58, s3, 3
    s_cmp_ge_u32 s58, 7
    s_cselect_b32 s59, 7, 0
    s_sub_u32 s58, s58, s59
    s_mul_i32 s59, s48, 7
    s_add_u32 s58, s58, s59
    s_lshl_b32 s63, s58, 11
    s_add_u32 s63, s63, s62
    s_add_u32 s61, s63, 57344
    buffer_load_dwordx4 v[64:67], v2, s[44:47], s63 offen offset:0 sc1
    buffer_load_dwordx4 v[68:71], v2, s[44:47], s61 offen offset:0 sc1
    buffer_load_dwordx4 v[72:75], v2, s[44:47], s63 offen offset:1024 sc1
    buffer_load_dwordx4 v[76:79], v2, s[44:47], s61 offen offset:1024 sc1
    s_waitcnt vmcnt(15)
    v_mfma_f32_32x32x16_bf16 v[80:95], v[144:147], v[16:19], 0
    v_mfma_f32_32x32x16_bf16 v[112:127], v[148:151], v[16:19], 0
    ds_write_b32 v3, v15 offset:16
    s_waitcnt vmcnt(14)
    v_mfma_f32_32x32x16_bf16 v[96:111], v[144:147], v[20:23], 0
    v_mfma_f32_32x32x16_bf16 v[128:143], v[148:151], v[20:23], 0
    s_add_u32 s58, s3, 4
    s_cmp_ge_u32 s58, 7
    s_cselect_b32 s59, 7, 0
    s_sub_u32 s58, s58, s59
    s_mul_i32 s59, s48, 7
    s_add_u32 s58, s58, s59
    s_lshl_b32 s63, s58, 11
    s_add_u32 s63, s63, s62
    s_add_u32 s61, s63, 57344
    buffer_load_dwordx4 v[16:19], v2, s[44:47], s63 offen offset:0 sc1
    s_waitcnt vmcnt(14)
    v_mfma_f32_32x32x16_bf16 v[80:95], v[152:155], v[24:27], v[80:95]
    v_mfma_f32_32x32x16_bf16 v[112:127], v[156:159], v[24:27], v[112:127]
    buffer_load_dwordx4 v[20:23], v2, s[44:47], s61 offen offset:0 sc1
    s_waitcnt vmcnt(14)
    v_mfma_f32_32x32x16_bf16 v[96:111], v[152:155], v[28:31], v[96:111]
    v_mfma_f32_32x32x16_bf16 v[128:143], v[156:159], v[28:31], v[128:143]
    buffer_load_dwordx4 v[24:27], v2, s[44:47], s63 offen offset:1024 sc1
    s_waitcnt vmcnt(14)
    v_mfma_f32_32x32x16_bf16 v[80:95], v[160:163], v[32:35], v[80:95]
    v_mfma_f32_32x32x16_bf16 v[112:127], v[164:167], v[32:35], v[112:127]
    buffer_load_dwordx4 v[28:31], v2, s[44:47], s61 offen offset:1024 sc1
    s_waitcnt vmcnt(14)
    v_mfma_f32_32x32x16_bf16 v[96:111], v[160:163], v[36:39], v[96:111]
    v_mfma_f32_32x32x16_bf16 v[128:143], v[164:167], v[36:39], v[128:143]
    s_add_u32 s58, s3, 5
    s_cmp_ge_u32 s58, 7
    s_cselect_b32 s59, 7, 0
    s_sub_u32 s58, s58, s59
    s_mul_i32 s59, s48, 7
    s_add_u32 s58, s58, s59
    s_lshl_b32 s63, s58, 11
    s_add_u32 s63, s63, s62
    s_add_u32 s61, s63, 57344
    buffer_load_dwordx4 v[32:35], v2, s[44:47], s63 offen offset:0 sc1
    s_waitcnt vmcnt(14)
    v_mfma_f32_32x32x16_bf16 v[80:95], v[168:171], v[40:43], v[80:95]
    v_mfma_f32_32x32x16_bf16 v[112:127], v[172:175], v[40:43], v[112:127]
    buffer_load_dwordx4 v[36:39], v2, s[44:47], s61 offen offset:0 sc1
    s_waitcnt vmcnt(14)
    v_mfma_f32_32x32x16_bf16 v[96:111], v[168:171], v[44:47], v[96:111]
    v_mfma_f32_32x32x16_bf16 v[128:143], v[172:175], v[44:47], v[128:143]
    buffer_load_dwordx4 v[40:43], v2, s[44:47], s63 offen offset:1024 sc1
    s_waitcnt vmcnt(14)
    v_mfma_f32_32x32x16_bf16 v[80:95], v[176:179], v[48:51], v[80:95]
    v_mfma_f32_32x32x16_bf16 v[112:127], v[180:183], v[48:51], v[112:127]
    buffer_load_dwordx4 v[44:47], v2, s[44:47], s61 offen offset:1024 sc1
    s_waitcnt vmcnt(14)
    v_mfma_f32_32x32x16_bf16 v[96:111], v[176:179], v[52:55], v[96:111]
    v_mfma_f32_32x32x16_bf16 v[128:143], v[180:183], v[52:55], v[128:143]
    s_add_u32 s58, s3, 6
    s_cmp_ge_u32 s58, 7
    s_cselect_b32 s59, 7, 0
    s_sub_u32 s58, s58, s59
    s_mul_i32 s59, s48, 7
    s_add_u32 s58, s58, s59
    s_lshl_b32 s63, s58, 11
    s_add_u32 s63, s63, s62
    s_add_u32 s61, s63, 57344
    buffer_load_dwordx4 v[48:51], v2, s[44:47], s63 offen offset:0 sc1
    s_waitcnt vmcnt(14)
    v_mfma_f32_32x32x16_bf16 v[80:95], v[184:187], v[56:59], v[80:95]
    v_mfma_f32_32x32x16_bf16 v[112:127], v[188:191], v[56:59], v[112:127]
    buffer_load_dwordx4 v[52:55], v2, s[44:47], s61 offen offset:0 sc1
    s_waitcnt vmcnt(14)
    v_mfma_f32_32x32x16_bf16 v[96:111], v[184:187], v[60:63], v[96:111]
    v_mfma_f32_32x32x16_bf16 v[128:143], v[188:191], v[60:63], v[128:143]
    buffer_load_dwordx4 v[56:59], v2, s[44:47], s63 offen offset:1024 sc1
    s_waitcnt vmcnt(14)
    v_mfma_f32_32x32x16_bf16 v[80:95], v[192:195], v[64:67], v[80:95]
    v_mfma_f32_32x32x16_bf16 v[112:127], v[196:199], v[64:67], v[112:127]
    buffer_load_dwordx4 v[60:63], v2, s[44:47], s61 offen offset:1024 sc1
    s_waitcnt vmcnt(14)
    v_mfma_f32_32x32x16_bf16 v[96:111], v[192:195], v[68:71], v[96:111]
    v_mfma_f32_32x32x16_bf16 v[128:143], v[196:199], v[68:71], v[128:143]
    s_waitcnt vmcnt(13)
    v_mfma_f32_32x32x16_bf16 v[80:95], v[200:203], v[72:75], v[80:95]
    v_mfma_f32_32x32x16_bf16 v[112:127], v[204:207], v[72:75], v[112:127]
    s_waitcnt vmcnt(12)
    v_mfma_f32_32x32x16_bf16 v[96:111], v[200:203], v[76:79], v[96:111]
    v_mfma_f32_32x32x16_bf16 v[128:143], v[204:207], v[76:79], v[128:143]
    v_and_b32 v6, 31, v1
    v_lshrrev_b32 v7, 5, v1
    s_lshl_b32 s68, s51, 6
    v_add_u32 v6, s68, v6
    v_lshlrev_b32 v4, 4, v6
    s_mov_b32 s71, 65536
    buffer_load_dwordx2 v[144:145], v4, s[44:47], s71 offen offset:0 sc1
    buffer_load_dwordx2 v[146:147], v4, s[44:47], s71 offen offset:512 sc1
    v_mul_u32_u24 v4, 896, v6
    v_lshl_add_u32 v4, v7, 4, v4
    s_lshl_b32 s71, s54, 7
    s_lshl_b32 s73, s48, 5
    s_add_u32 s71, s71, s73
    s_add_u32 s72, s71, 28672
    buffer_load_dwordx4 v[148:151], v4, s[4:7], s71 offen
    buffer_load_dwordx4 v[152:155], v4, s[4:7], s72 offen
    v_and_b32 v5, 0x7f8, v6
    v_and_b32 v9, 1, v6
    v_lshl_add_u32 v5, v9, 2, v5
    v_bfe_u32 v9, v6, 1, 2
    v_add_u32 v5, v5, v9
    v_lshlrev_b32 v5, 2, v5
    v_lshl_add_u32 v5, v7, 15, v5
    s_lshl_b32 s73, s54, 5
    s_lshl_b32 s75, s48, 3
    s_add_u32 s73, s73, s75
    s_lshl_b32 s73, s73, 13
    s_add_u32 s73, s73, 2097152
    s_lshl_b32 s75, s54, 9
    s_lshr_b32 s76, s51, 3
    s_lshl_b32 s76, s76, 7
    s_add_u32 s75, s75, s76
    s_lshl_b32 s76, s48, 5
    s_add_u32 s75, s75, s76
    s_add_u32 s75, s75, 24576
    s_waitcnt vmcnt(15)
    v_mfma_f32_32x32x16_bf16 v[80:95], v[208:211], v[16:19], v[80:95]
    v_mfma_f32_32x32x16_bf16 v[112:127], v[212:215], v[16:19], v[112:127]
    s_waitcnt vmcnt(14)
    v_mfma_f32_32x32x16_bf16 v[96:111], v[208:211], v[20:23], v[96:111]
    v_mfma_f32_32x32x16_bf16 v[128:143], v[212:215], v[20:23], v[128:143]
    s_waitcnt vmcnt(13)
    v_mfma_f32_32x32x16_bf16 v[80:95], v[216:219], v[24:27], v[80:95]
    v_mfma_f32_32x32x16_bf16 v[112:127], v[220:223], v[24:27], v[112:127]
    s_waitcnt vmcnt(12)
    v_mfma_f32_32x32x16_bf16 v[96:111], v[216:219], v[28:31], v[96:111]
    v_mfma_f32_32x32x16_bf16 v[128:143], v[220:223], v[28:31], v[128:143]
    s_waitcnt vmcnt(11)
    v_mfma_f32_32x32x16_bf16 v[80:95], v[224:227], v[32:35], v[80:95]
    v_mfma_f32_32x32x16_bf16 v[112:127], v[228:231], v[32:35], v[112:127]
    s_waitcnt vmcnt(10)
    v_mfma_f32_32x32x16_bf16 v[96:111], v[224:227], v[36:39], v[96:111]
    v_mfma_f32_32x32x16_bf16 v[128:143], v[228:231], v[36:39], v[128:143]
    s_waitcnt vmcnt(9)
    v_mfma_f32_32x32x16_bf16 v[80:95], v[232:235], v[40:43], v[80:95]
    v_mfma_f32_32x32x16_bf16 v[112:127], v[236:239], v[40:43], v[112:127]
    s_waitcnt vmcnt(8)
    v_mfma_f32_32x32x16_bf16 v[96:111], v[232:235], v[44:47], v[96:111]
    v_mfma_f32_32x32x16_bf16 v[128:143], v[236:239], v[44:47], v[128:143]
    s_waitcnt vmcnt(7)
    v_mfma_f32_32x32x16_bf16 v[80:95], v[240:243], v[48:51], v[80:95]
    v_mfma_f32_32x32x16_bf16 v[112:127], v[244:247], v[48:51], v[112:127]
    s_waitcnt vmcnt(6)
    v_mfma_f32_32x32x16_bf16 v[96:111], v[240:243], v[52:55], v[96:111]
    v_mfma_f32_32x32x16_bf16 v[128:143], v[244:247], v[52:55], v[128:143]
    s_waitcnt vmcnt(5)
    v_mfma_f32_32x32x16_bf16 v[80:95], v[248:251], v[56:59], v[80:95]
    v_mfma_f32_32x32x16_bf16 v[112:127], v[252:255], v[56:59], v[112:127]
    s_waitcnt vmcnt(4)
    v_mfma_f32_32x32x16_bf16 v[96:111], v[248:251], v[60:63], v[96:111]
    v_mfma_f32_32x32x16_bf16 v[128:143], v[252:255], v[60:63], v[128:143]
    s_setprio 0
    s_nop 7
    s_mov_b32 s58, 0
L_lw4:
    ds_read_b32 v8, v3 offset:32
    s_waitcnt lgkmcnt(0)
    v_cmp_ne_u32 vcc, s78, v8
    s_cbranch_vccz L_lwd4
    s_add_u32 s58, s58, 1
    s_cmp_lt_u32 s58, 0x400000
    s_cbranch_scc0 L_lwd4
    s_sleep 1
    s_branch L_lw4
L_lwd4:
    v_add_u32 v9, s57, v2
    ds_write_b128 v9, v[80:83] offset:0
    ds_write_b128 v9, v[84:87] offset:1024
    ds_write_b128 v9, v[88:91] offset:16384
    ds_write_b128 v9, v[92:95] offset:17408
    ds_write_b128 v9, v[112:115] offset:32768
    ds_write_b128 v9, v[116:119] offset:33792
    ds_write_b128 v9, v[120:123] offset:49152
    ds_write_b128 v9, v[124:127] offset:50176
    ds_write_b128 v9, v[96:99] offset:2048
    ds_write_b128 v9, v[100:103] offset:3072
    ds_write_b128 v9, v[104:107] offset:18432
    ds_write_b128 v9, v[108:111] offset:19456
    ds_write_b128 v9, v[128:131] offset:34816
    ds_write_b128 v9, v[132:135] offset:35840
    ds_write_b128 v9, v[136:139] offset:51200
    ds_write_b128 v9, v[140:143] offset:52224
    ds_write_b32 v3, v15 offset:112
    s_lshl_b32 s76, s48, 14
    v_add_u32 v9, s76, v2
    v_add_u32 v10, 0x10000, v9
    s_mov_b32 s58, 0
L_lw5:
    ds_read_b32 v8, v0 offset:112
    s_waitcnt lgkmcnt(0)
    v_cmp_ne_u32 vcc, s78, v8
    s_cbranch_vccz L_lwd5
    s_add_u32 s58, s58, 1
    s_cmp_lt_u32 s58, 0x400000
    s_cbranch_scc0 L_lwd5
    s_sleep 1
    s_branch L_lw5
L_lwd5:
    ds_read_b128 v[16:19], v9 offset:0
    ds_read_b128 v[20:23], v9 offset:1024
    ds_read_b128 v[24:27], v9 offset:4096
    ds_read_b128 v[28:31], v9 offset:5120
    ds_read_b128 v[32:35], v9 offset:8192
    ds_read_b128 v[36:39], v9 offset:9216
    ds_read_b128 v[40:43], v9 offset:12288
    ds_read_b128 v[44:47], v9 offset:13312
    ds_read_b128 v[48:51], v9 offset:2048
    ds_read_b128 v[52:55], v9 offset:3072
    ds_read_b128 v[56:59], v9 offset:6144
    ds_read_b128 v[60:63], v9 offset:7168
    ds_read_b128 v[64:67], v9 offset:10240
    ds_read_b128 v[68:71], v9 offset:11264
    ds_read_b128 v[72:75], v9 offset:14336
    ds_read_b128 v[76:79], v9 offset:15360
    s_mov_b32 s58, 0
L_sp6:
    s_load_dwordx8 s[8:15], s[44:45], s75 glc
    s_waitcnt lgkmcnt(0)
    s_xor_b64 s[8:9], s[8:9], s[78:79]
    s_xor_b64 s[10:11], s[10:11], s[78:79]
    s_xor_b64 s[12:13], s[12:13], s[78:79]
    s_xor_b64 s[14:15], s[14:15], s[78:79]
    s_or_b64 s[8:9], s[8:9], s[10:11]
    s_or_b64 s[12:13], s[12:13], s[14:15]
    s_or_b64 s[8:9], s[8:9], s[12:13]
    s_cbranch_scc0 L_spd6
    s_add_u32 s58, s58, 1
    s_cmp_lt_u32 s58, 0x40000
    s_sleep 8
    s_cbranch_scc1 L_sp6
L_spd6:
    buffer_load_dword v156, v5, s[44:47], s73 offen offset:0 sc1
    buffer_load_dword v160, v5, s[44:47], s73 offen offset:128 sc1
    s_add_u32 s73, s73, 8192
    buffer_load_dword v157, v5, s[44:47], s73 offen offset:0 sc1
    buffer_load_dword v161, v5, s[44:47], s73 offen offset:128 sc1
    s_add_u32 s73, s73, 8192
    buffer_load_dword v158, v5, s[44:47], s73 offen offset:0 sc1
    buffer_load_dword v162, v5, s[44:47], s73 offen offset:128 sc1
    s_add_u32 s73, s73, 8192
    buffer_load_dword v159, v5, s[44:47], s73 offen offset:0 sc1
    buffer_load_dword v163, v5, s[44:47], s73 offen offset:128 sc1
    s_add_u32 s73, s73, 8192
    s_waitcnt vmcnt(8)
    v_lshlrev_b32 v176, 16, v148
    v_and_b32 v177, 0xffff0000, v148
    v_lshlrev_b32 v178, 16, v149
    v_and_b32 v179, 0xffff0000, v149
    v_lshlrev_b32 v180, 16, v150
    v_and_b32 v181, 0xffff0000, v150
    v_lshlrev_b32 v182, 16, v151
    v_and_b32 v183, 0xffff0000, v151
    v_sub_f32 v192, v176, v144
    v_mul_f32 v192, v192, v145
    v_sub_f32 v193, v177, v144
    v_mul_f32 v193, v193, v145
    v_sub_f32 v194, v178, v144
    v_mul_f32 v194, v194, v145
    v_sub_f32 v195, v179, v144
    v_mul_f32 v195, v195, v145
    v_sub_f32 v196, v180, v144
    v_mul_f32 v196, v196, v145
    v_sub_f32 v197, v181, v144
    v_mul_f32 v197, v197, v145
    v_sub_f32 v198, v182, v144
    v_mul_f32 v198, v198, v145
    v_sub_f32 v199, v183, v144
    v_mul_f32 v199, v199, v145
    v_mul_f32 v145, v145, v145
    v_lshlrev_b32 v184, 16, v152
    v_and_b32 v185, 0xffff0000, v152
    v_lshlrev_b32 v186, 16, v153
    v_and_b32 v187, 0xffff0000, v153
    v_lshlrev_b32 v188, 16, v154
    v_and_b32 v189, 0xffff0000, v154
    v_lshlrev_b32 v190, 16, v155
    v_and_b32 v191, 0xffff0000, v155
    v_sub_f32 v200, v184, v146
    v_mul_f32 v200, v200, v147
    v_sub_f32 v201, v185, v146
    v_mul_f32 v201, v201, v147
    v_sub_f32 v202, v186, v146
    v_mul_f32 v202, v202, v147
    v_sub_f32 v203, v187, v146
    v_mul_f32 v203, v203, v147
    v_sub_f32 v204, v188, v146
    v_mul_f32 v204, v204, v147
    v_sub_f32 v205, v189, v146
    v_mul_f32 v205, v205, v147
    v_sub_f32 v206, v190, v146
    v_mul_f32 v206, v206, v147
    v_sub_f32 v207, v191, v146
    v_mul_f32 v207, v207, v147
    v_mul_f32 v147, v147, v147
    s_waitcnt lgkmcnt(0)
    v_add_f32 v16, v16, v24
    v_add_f32 v32, v32, v40
    v_add_f32 v17, v17, v25
    v_add_f32 v33, v33, v41
    v_add_f32 v18, v18, v26
    v_add_f32 v34, v34, v42
    v_add_f32 v19, v19, v27
    v_add_f32 v35, v35, v43
    v_add_f32 v20, v20, v28
    v_add_f32 v36, v36, v44
    v_add_f32 v21, v21, v29
    v_add_f32 v37, v37, v45
    v_add_f32 v22, v22, v30
    v_add_f32 v38, v38, v46
    v_add_f32 v23, v23, v31
    v_add_f32 v39, v39, v47
    v_add_f32 v208, v16, v32
    v_add_f32 v209, v17, v33
    v_add_f32 v210, v18, v34
    v_add_f32 v211, v19, v35
    v_add_f32 v212, v20, v36
    v_add_f32 v213, v21, v37
    v_add_f32 v214, v22, v38
    v_add_f32 v215, v23, v39
    v_add_f32 v48, v48, v56
    v_add_f32 v64, v64, v72
    v_add_f32 v49, v49, v57
    v_add_f32 v65, v65, v73
    v_add_f32 v50, v50, v58
    v_add_f32 v66, v66, v74
    v_add_f32 v51, v51, v59
    v_add_f32 v67, v67, v75
    v_add_f32 v52, v52, v60
    v_add_f32 v68, v68, v76
    v_add_f32 v53, v53, v61
    v_add_f32 v69, v69, v77
    v_add_f32 v54, v54, v62
    v_add_f32 v70, v70, v78
    v_add_f32 v55, v55, v63
    v_add_f32 v71, v71, v79
    v_add_f32 v216, v48, v64
    v_add_f32 v217, v49, v65
    v_add_f32 v218, v50, v66
    v_add_f32 v219, v51, v67
    v_add_f32 v220, v52, v68
    v_add_f32 v221, v53, v69
    v_add_f32 v222, v54, v70
    v_add_f32 v223, v55, v71
    s_waitcnt vmcnt(0)
    v_lshlrev_b32 v224, 16, v156
    v_and_b32 v225, 0xffff0000, v156
    v_lshlrev_b32 v226, 16, v157
    v_and_b32 v227, 0xffff0000, v157
    v_lshlrev_b32 v228, 16, v158
    v_and_b32 v229, 0xffff0000, v158
    v_lshlrev_b32 v230, 16, v159
    v_and_b32 v231, 0xffff0000, v159
    v_fmac_f32 v176, v192, v224
    v_fmac_f32 v177, v193, v225
    v_fmac_f32 v178, v194, v226
    v_fmac_f32 v179, v195, v227
    v_fmac_f32 v180, v196, v228
    v_fmac_f32 v181, v197, v229
    v_fmac_f32 v182, v198, v230
    v_fmac_f32 v183, v199, v231
    v_lshlrev_b32 v224, 16, v160
    v_and_b32 v225, 0xffff0000, v160
    v_lshlrev_b32 v226, 16, v161
    v_and_b32 v227, 0xffff0000, v161
    v_lshlrev_b32 v228, 16, v162
    v_and_b32 v229, 0xffff0000, v162
    v_lshlrev_b32 v230, 16, v163
    v_and_b32 v231, 0xffff0000, v163
    v_fmac_f32 v184, v200, v224
    v_fmac_f32 v185, v201, v225
    v_fmac_f32 v186, v202, v226
    v_fmac_f32 v187, v203, v227
    v_fmac_f32 v188, v204, v228
    v_fmac_f32 v189, v205, v229
    v_fmac_f32 v190, v206, v230
    v_fmac_f32 v191, v207, v231
    s_mov_b32 s58, 0
L_lw7:
    ds_read_b32 v8, v0 offset:128
    s_waitcnt lgkmcnt(0)
    v_cmp_ne_u32 vcc, s78, v8
    s_cbranch_vccz L_lwd7
    s_add_u32 s58, s58, 1
    s_cmp_lt_u32 s58, 0x400000
    s_cbranch_scc0 L_lwd7
    s_sleep 1
    s_branch L_lw7
L_lwd7:
    ds_read_b128 v[16:19], v10 offset:0
    ds_read_b128 v[20:23], v10 offset:1024
    ds_read_b128 v[24:27], v10 offset:4096
    ds_read_b128 v[28:31], v10 offset:5120
    ds_read_b128 v[32:35], v10 offset:8192
    ds_read_b128 v[36:39], v10 offset:9216
    ds_read_b128 v[40:43], v10 offset:12288
    ds_read_b128 v[44:47], v10 offset:13312
    ds_read_b128 v[48:51], v10 offset:2048
    ds_read_b128 v[52:55], v10 offset:3072
    ds_read_b128 v[56:59], v10 offset:6144
    ds_read_b128 v[60:63], v10 offset:7168
    ds_read_b128 v[64:67], v10 offset:10240
    ds_read_b128 v[68:71], v10 offset:11264
    ds_read_b128 v[72:75], v10 offset:14336
    ds_read_b128 v[76:79], v10 offset:15360
    s_waitcnt lgkmcnt(8)
    v_add_f32 v16, v16, v24
    v_add_f32 v32, v32, v40
    v_add_f32 v17, v17, v25
    v_add_f32 v33, v33, v41
    v_add_f32 v18, v18, v26
    v_add_f32 v34, v34, v42
    v_add_f32 v19, v19, v27
    v_add_f32 v35, v35, v43
    v_add_f32 v20, v20, v28
    v_add_f32 v36, v36, v44
    v_add_f32 v21, v21, v29
    v_add_f32 v37, v37, v45
    v_add_f32 v22, v22, v30
    v_add_f32 v38, v38, v46
    v_add_f32 v23, v23, v31
    v_add_f32 v39, v39, v47
    v_add_f32 v16, v16, v208
    v_add_f32 v17, v17, v209
    v_add_f32 v18, v18, v210
    v_add_f32 v19, v19, v211
    v_add_f32 v20, v20, v212
    v_add_f32 v21, v21, v213
    v_add_f32 v22, v22, v214
    v_add_f32 v23, v23, v215
    v_add_f32 v16, v16, v32
    v_add_f32 v17, v17, v33
    v_add_f32 v18, v18, v34
    v_add_f32 v19, v19, v35
    v_add_f32 v20, v20, v36
    v_add_f32 v21, v21, v37
    v_add_f32 v22, v22, v38
    v_add_f32 v23, v23, v39
    v_permlane32_swap_b32 v16, v20
    v_permlane32_swap_b32 v17, v21
    v_permlane32_swap_b32 v18, v22
    v_permlane32_swap_b32 v19, v23
    v_fmac_f32 v176, v145, v16
    v_fmac_f32 v177, v145, v17
    v_fmac_f32 v178, v145, v18
    v_fmac_f32 v179, v145, v19
    v_fmac_f32 v180, v145, v20
    v_fmac_f32 v181, v145, v21
    v_fmac_f32 v182, v145, v22
    v_fmac_f32 v183, v145, v23
    v_cvt_pk_bf16_f32 v224, v176, v177
    v_cvt_pk_bf16_f32 v225, v178, v179
    v_cvt_pk_bf16_f32 v226, v180, v181
    v_cvt_pk_bf16_f32 v227, v182, v183
    buffer_store_dwordx4 v[224:227], v4, s[40:43], s71 offen
    s_waitcnt lgkmcnt(0)
    v_add_f32 v48, v48, v56
    v_add_f32 v64, v64, v72
    v_add_f32 v49, v49, v57
    v_add_f32 v65, v65, v73
    v_add_f32 v50, v50, v58
    v_add_f32 v66, v66, v74
    v_add_f32 v51, v51, v59
    v_add_f32 v67, v67, v75
    v_add_f32 v52, v52, v60
    v_add_f32 v68, v68, v76
    v_add_f32 v53, v53, v61
    v_add_f32 v69, v69, v77
    v_add_f32 v54, v54, v62
    v_add_f32 v70, v70, v78
    v_add_f32 v55, v55, v63
    v_add_f32 v71, v71, v79
    v_add_f32 v48, v48, v216
    v_add_f32 v49, v49, v217
    v_add_f32 v50, v50, v218
    v_add_f32 v51, v51, v219
    v_add_f32 v52, v52, v220
    v_add_f32 v53, v53, v221
    v_add_f32 v54, v54, v222
    v_add_f32 v55, v55, v223
    v_add_f32 v48, v48, v64
    v_add_f32 v49, v49, v65
    v_add_f32 v50, v50, v66
    v_add_f32 v51, v51, v67
    v_add_f32 v52, v52, v68
    v_add_f32 v53, v53, v69
    v_add_f32 v54, v54, v70
    v_add_f32 v55, v55, v71
    v_permlane32_swap_b32 v48, v52
    v_permlane32_swap_b32 v49, v53
    v_permlane32_swap_b32 v50, v54
    v_permlane32_swap_b32 v51, v55
    v_fmac_f32 v184, v147, v48
    v_fmac_f32 v185, v147, v49
    v_fmac_f32 v186, v147, v50
    v_fmac_f32 v187, v147, v51
    v_fmac_f32 v188, v147, v52
    v_fmac_f32 v189, v147, v53
    v_fmac_f32 v190, v147, v54
    v_fmac_f32 v191, v147, v55
    v_cvt_pk_bf16_f32 v228, v184, v185
    v_cvt_pk_bf16_f32 v229, v186, v187
    v_cvt_pk_bf16_f32 v230, v188, v189
    v_cvt_pk_bf16_f32 v231, v190, v191
    buffer_store_dwordx4 v[228:231], v4, s[40:43], s72 offen
    s_branch L_fin
L_spare:
    s_lshl_b32 s60, s52, 2
    s_add_u32 s60, s60, s56
    v_lshrrev_b32 v2, 3, v0
    v_and_b32 v3, 7, v0
    v_mul_u32_u24 v4, 896, v2
    v_lshl_add_u32 v4, v3, 4, v4
    s_mul_i32 s61, s60, 57344
    s_waitcnt lgkmcnt(0)
    s_load_dword s78, s[44:45], 0
    buffer_load_dwordx4 v[8:11], v4, s[4:7], s61 offen offset:0
    buffer_load_dwordx4 v[12:15], v4, s[4:7], s61 offen offset:128
    buffer_load_dwordx4 v[16:19], v4, s[4:7], s61 offen offset:256
    buffer_load_dwordx4 v[20:23], v4, s[4:7], s61 offen offset:384
    buffer_load_dwordx4 v[24:27], v4, s[4:7], s61 offen offset:512
    buffer_load_dwordx4 v[28:31], v4, s[4:7], s61 offen offset:640
    buffer_load_dwordx4 v[32:35], v4, s[4:7], s61 offen offset:768
    s_lshr_b32 s62, s52, 1
    s_lshl_b32 s62, s62, 2
    s_add_u32 s62, s62, s56
    s_min_u32 s62, s62, 13
    s_cmp_ge_u32 s62, 7
    s_cselect_b32 s64, s32, s28
    s_cselect_b32 s65, s33, s29
    s_cselect_b32 s63, 7, 0
    s_cselect_b32 s68, 28672, 0
    s_mov_b32 s66, 1605632
    s_mov_b32 s67, 0x20000
    s_sub_u32 s63, s62, s63
    s_and_b32 s69, s52, 1
    s_mul_i32 s69, s69, 7
    s_add_u32 s63, s63, s69
    v_lshrrev_b32 v6, 4, v1
    v_and_b32 v5, 15, v1
    v_mul_u32_u24 v7, 3584, v6
    v_lshl_add_u32 v7, v5, 4, v7
    s_mul_i32 s69, s55, 200704
    s_lshl_b32 s70, s63, 8
    s_add_u32 s69, s69, s70
    buffer_load_dwordx4 v[64:67], v7, s[64:67], s69 offen
    s_add_u32 s69, s69, 14336
    buffer_load_dwordx4 v[68:71], v7, s[64:67], s69 offen
    s_add_u32 s69, s69, 14336
    buffer_load_dwordx4 v[72:75], v7, s[64:67], s69 offen
    s_add_u32 s69, s69, 14336
    buffer_load_dwordx4 v[76:79], v7, s[64:67], s69 offen
    s_add_u32 s69, s69, 14336
    buffer_load_dwordx4 v[80:83], v7, s[64:67], s69 offen
    s_add_u32 s69, s69, 14336
    buffer_load_dwordx4 v[84:87], v7, s[64:67], s69 offen
    s_add_u32 s69, s69, 14336
    buffer_load_dwordx4 v[88:91], v7, s[64:67], s69 offen
    s_add_u32 s69, s69, 14336
    buffer_load_dwordx4 v[92:95], v7, s[64:67], s69 offen
    s_add_u32 s69, s69, 14336
    buffer_load_dwordx4 v[96:99], v7, s[64:67], s69 offen
    s_add_u32 s69, s69, 14336
    buffer_load_dwordx4 v[100:103], v7, s[64:67], s69 offen
    s_add_u32 s69, s69, 14336
    buffer_load_dwordx4 v[104:107], v7, s[64:67], s69 offen
    s_add_u32 s69, s69, 14336
    buffer_load_dwordx4 v[108:111], v7, s[64:67], s69 offen
    s_add_u32 s69, s69, 14336
    buffer_load_dwordx4 v[112:115], v7, s[64:67], s69 offen
    s_add_u32 s69, s69, 14336
    buffer_load_dwordx4 v[116:119], v7, s[64:67], s69 offen
    s_add_u32 s69, s69, 14336
    v_lshrrev_b32 v44, 1, v5
    v_and_b32 v45, 1, v5
    v_lshlrev_b32 v45, 4, v45
    v_mov_b32 v46, 0x3f80
    v_lshlrev_b32 v46, v45, v46
    v_cmp_eq_u32 vcc, 0, v44
    s_nop 1
    v_cndmask_b32 v48, 0, v46, vcc
    v_cmp_eq_u32 vcc, 1, v44
    s_nop 1
    v_cndmask_b32 v49, 0, v46, vcc
    v_cmp_eq_u32 vcc, 2, v44
    s_nop 1
    v_cndmask_b32 v50, 0, v46, vcc
    v_cmp_eq_u32 vcc, 3, v44
    s_nop 1
    v_cndmask_b32 v51, 0, v46, vcc
    s_waitcnt lgkmcnt(0)
    s_mul_i32 s77, s78, 0x9E3779B1
    s_add_u32 s77, s77, 0x7F4A7C15
    s_lshr_b32 s78, s77, 15
    s_xor_b32 s78, s78, s77
    s_and_b32 s78, s78, 0xBFFFBFFF
    s_mov_b32 s79, s78
    v_mov_b32 v40, 0
    v_mov_b32 v41, 0
    v_mov_b32 v42, 0
    v_mov_b32 v43, 0
    s_mov_b32 s70, 0x3f803f80
    s_waitcnt vmcnt(14)
    v_dot2_f32_bf16 v40, v8, s70, v40
    v_dot2_f32_bf16 v41, v8, v8, v41
    v_dot2_f32_bf16 v42, v9, s70, v42
    v_dot2_f32_bf16 v43, v9, v9, v43
    v_dot2_f32_bf16 v40, v10, s70, v40
    v_dot2_f32_bf16 v41, v10, v10, v41
    v_dot2_f32_bf16 v42, v11, s70, v42
    v_dot2_f32_bf16 v43, v11, v11, v43
    v_dot2_f32_bf16 v40, v12, s70, v40
    v_dot2_f32_bf16 v41, v12, v12, v41
    v_dot2_f32_bf16 v42, v13, s70, v42
    v_dot2_f32_bf16 v43, v13, v13, v43
    v_dot2_f32_bf16 v40, v14, s70, v40
    v_dot2_f32_bf16 v41, v14, v14, v41
    v_dot2_f32_bf16 v42, v15, s70, v42
    v_dot2_f32_bf16 v43, v15, v15, v43
    v_dot2_f32_bf16 v40, v16, s70, v40
    v_dot2_f32_bf16 v41, v16, v16, v41
    v_dot2_f32_bf16 v42, v17, s70, v42
    v_dot2_f32_bf16 v43, v17, v17, v43
    v_dot2_f32_bf16 v40, v18, s70, v40
    v_dot2_f32_bf16 v41, v18, v18, v41
    v_dot2_f32_bf16 v42, v19, s70, v42
    v_dot2_f32_bf16 v43, v19, v19, v43
    v_dot2_f32_bf16 v40, v20, s70, v40
    v_dot2_f32_bf16 v41, v20, v20, v41
    v_dot2_f32_bf16 v42, v21, s70, v42
    v_dot2_f32_bf16 v43, v21, v21, v43
    v_dot2_f32_bf16 v40, v22, s70, v40
    v_dot2_f32_bf16 v41, v22, v22, v41
    v_dot2_f32_bf16 v42, v23, s70, v42
    v_dot2_f32_bf16 v43, v23, v23, v43
    v_dot2_f32_bf16 v40, v24, s70, v40
    v_dot2_f32_bf16 v41, v24, v24, v41
    v_dot2_f32_bf16 v42, v25, s70, v42
    v_dot2_f32_bf16 v43, v25, v25, v43
    v_dot2_f32_bf16 v40, v26, s70, v40
    v_dot2_f32_bf16 v41, v26, v26, v41
    v_dot2_f32_bf16 v42, v27, s70, v42
    v_dot2_f32_bf16 v43, v27, v27, v43
    v_dot2_f32_bf16 v40, v28, s70, v40
    v_dot2_f32_bf16 v41, v28, v28, v41
    v_dot2_f32_bf16 v42, v29, s70, v42
    v_dot2_f32_bf16 v43, v29, v29, v43
    v_dot2_f32_bf16 v40, v30, s70, v40
    v_dot2_f32_bf16 v41, v30, v30, v41
    v_dot2_f32_bf16 v42, v31, s70, v42
    v_dot2_f32_bf16 v43, v31, v31, v43
    v_dot2_f32_bf16 v40, v32, s70, v40
    v_dot2_f32_bf16 v41, v32, v32, v41
    v_dot2_f32_bf16 v42, v33, s70, v42
    v_dot2_f32_bf16 v43, v33, v33, v43
    v_dot2_f32_bf16 v40, v34, s70, v40
    v_dot2_f32_bf16 v41, v34, v34, v41
    v_dot2_f32_bf16 v42, v35, s70, v42
    v_dot2_f32_bf16 v43, v35, v35, v43
    s_nop 1
    v_add_f32 v40, v40, v42
    v_add_f32 v41, v41, v43
    s_nop 0
    v_add_f32_dpp v40, v40, v40 quad_perm:[1,0,3,2] row_mask:0xf bank_mask:0xf
    v_add_f32_dpp v41, v41, v41 quad_perm:[1,0,3,2] row_mask:0xf bank_mask:0xf
    s_nop 0
    v_add_f32_dpp v40, v40, v40 quad_perm:[2,3,0,1] row_mask:0xf bank_mask:0xf
    v_add_f32_dpp v41, v41, v41 quad_perm:[2,3,0,1] row_mask:0xf bank_mask:0xf
    s_nop 0
    v_add_f32_dpp v40, v40, v40 row_half_mirror row_mask:0xf bank_mask:0xf
    v_add_f32_dpp v41, v41, v41 row_half_mirror row_mask:0xf bank_mask:0xf
    v_mul_f32 v40, 0x3b124925, v40
    v_mul_f32 v41, 0x3b124925, v41
    v_fma_f32 v41, -v40, v40, v41
    v_max_f32 v41, 0, v41
    v_cvt_pk_bf16_f32 v40, v40, v40
    v_lshlrev_b32 v40, 16, v40
    v_cvt_pk_bf16_f32 v41, v41, v41
    v_lshlrev_b32 v41, 16, v41
    v_add_f32 v41, 0x3727c5ac, v41
    v_cvt_pk_bf16_f32 v41, v41, v41
    v_lshlrev_b32 v41, 16, v41
    v_sqrt_f32 v41, v41
    s_nop 0
    v_cvt_pk_bf16_f32 v41, v41, v41
    v_lshlrev_b32 v41, 16, v41
    v_rcp_f32 v41, v41
    v_mov_b32 v42, s78
    v_mov_b32 v43, 0
    v_lshlrev_b32 v4, 4, v2
    s_lshl_b32 s61, s60, 10
    s_add_u32 s61, s61, 65536
    v_cmp_eq_u32 vcc, 0, v3
    s_and_saveexec_b64 s[72:73], vcc
    buffer_store_dwordx4 v[40:43], v4, s[44:47], s61 offen sc1
    s_mov_b64 exec, s[72:73]
    s_waitcnt vmcnt(14)
    v_mfma_f32_16x16x32_bf16 v[52:55], v[48:51], v[64:67], 0
    s_waitcnt vmcnt(13)
    v_mfma_f32_16x16x32_bf16 v[52:55], v[48:51], v[68:71], v[52:55]
    s_waitcnt vmcnt(12)
    v_mfma_f32_16x16x32_bf16 v[52:55], v[48:51], v[72:75], v[52:55]
    s_waitcnt vmcnt(11)
    v_mfma_f32_16x16x32_bf16 v[52:55], v[48:51], v[76:79], v[52:55]
    s_waitcnt vmcnt(10)
    v_mfma_f32_16x16x32_bf16 v[52:55], v[48:51], v[80:83], v[52:55]
    s_waitcnt vmcnt(9)
    v_mfma_f32_16x16x32_bf16 v[52:55], v[48:51], v[84:87], v[52:55]
    s_waitcnt vmcnt(8)
    v_mfma_f32_16x16x32_bf16 v[52:55], v[48:51], v[88:91], v[52:55]
    s_waitcnt vmcnt(7)
    v_mfma_f32_16x16x32_bf16 v[52:55], v[48:51], v[92:95], v[52:55]
    s_waitcnt vmcnt(6)
    v_mfma_f32_16x16x32_bf16 v[52:55], v[48:51], v[96:99], v[52:55]
    s_waitcnt vmcnt(5)
    v_mfma_f32_16x16x32_bf16 v[52:55], v[48:51], v[100:103], v[52:55]
    s_waitcnt vmcnt(4)
    v_mfma_f32_16x16x32_bf16 v[52:55], v[48:51], v[104:107], v[52:55]
    s_waitcnt vmcnt(3)
    v_mfma_f32_16x16x32_bf16 v[52:55], v[48:51], v[108:111], v[52:55]
    s_waitcnt vmcnt(2)
    v_mfma_f32_16x16x32_bf16 v[52:55], v[48:51], v[112:115], v[52:55]
    s_waitcnt vmcnt(1)
    v_mfma_f32_16x16x32_bf16 v[52:55], v[48:51], v[116:119], v[52:55]
    v_lshlrev_b32 v4, 5, v5
    v_lshl_add_u32 v4, v6, 4, v4
    s_lshl_b32 s61, s55, 9
    v_add_u32 v4, s61, v4
    v_cmp_gt_u32 vcc, 2, v6
    s_and_saveexec_b64 s[72:73], vcc
    s_nop 1
    ds_write_b128 v4, v[52:55]
    s_mov_b64 exec, s[72:73]
    s_waitcnt lgkmcnt(0)
    s_barrier
    s_cmp_ge_u32 s55, 2
    s_cbranch_scc1 L_fin
    v_lshlrev_b32 v4, 2, v0
    ds_read_b32 v64, v4 offset:0
    ds_read_b32 v65, v4 offset:512
    ds_read_b32 v66, v4 offset:1024
    ds_read_b32 v67, v4 offset:1536
    ds_read_b32 v68, v4 offset:2048
    ds_read_b32 v69, v4 offset:2560
    ds_read_b32 v70, v4 offset:3072
    ds_read_b32 v71, v4 offset:3584
    s_waitcnt lgkmcnt(0)
    v_add_f32 v64, v64, v68
    v_add_f32 v65, v65, v69
    v_add_f32 v66, v66, v70
    v_add_f32 v67, v67, v71
    v_add_f32 v64, v64, v66
    v_add_f32 v65, v65, v67
    v_add_f32 v64, v64, v65
    v_and_b32 v70, 0xffff0000, v64
    v_sub_f32 v64, v64, v70
    v_and_b32 v72, 0xffff0000, v64
    v_sub_f32 v64, v64, v72
    v_lshrrev_b32 v70, 16, v70
    v_or_b32 v40, v70, v72
    v_lshrrev_b32 v41, 16, v64
    s_lshl_b32 s61, s63, 11
    s_add_u32 s61, s61, s68
    s_add_u32 s61, s61, 98304
    v_lshlrev_b32 v4, 4, v0
    buffer_store_dwordx4 v[40:43], v4, s[44:47], s61 offen sc1
    s_cmp_lg_u32 s55, 0
    s_cbranch_scc1 L_fin
    s_lshl_b32 s61, s60, 2
    s_add_u32 s61, s61, 12288
    v_mov_b32 v2, 0
    v_mov_b32 v3, s78
    s_mov_b64 exec, 1
    buffer_store_dword v3, v2, s[44:47], s61 offen sc1
    s_mov_b64 exec, -1
    s_cmp_lg_u32 s60, 0
    s_cbranch_scc1 L_fin
    v_and_b32 v4, 31, v0
    v_lshlrev_b32 v4, 2, v4
    s_mov_b32 s61, 12288
    s_mov_b32 s58, 0
L_poll8:
    buffer_load_dword v5, v4, s[44:47], s61 offen sc1
    s_waitcnt vmcnt(0)
    v_cmp_ne_u32 vcc, s78, v5
    s_cbranch_vccz L_polled8
    s_add_u32 s58, s58, 1
    s_cmp_lt_u32 s58, 0x40000
    s_cbranch_scc0 L_polled8
    s_sleep 8
    s_branch L_poll8
L_polled8:
    s_mov_b32 s61, 4096
L_sp_ep:
    s_mov_b32 s58, 0
L_poll9:
    buffer_load_dword v5, v4, s[44:47], s61 offen sc1
    s_waitcnt vmcnt(0)
    v_cmp_ne_u32 vcc, s78, v5
    s_cbranch_vccz L_polled9
    s_add_u32 s58, s58, 1
    s_cmp_lt_u32 s58, 0x40000
    s_cbranch_scc0 L_polled9
    s_sleep 8
    s_branch L_poll9
L_polled9:
    s_add_u32 s61, s61, 512
    s_cmp_lt_u32 s61, 7680
    s_cbranch_scc1 L_sp_ep
    v_mov_b32 v2, 0
    v_mov_b32 v3, s77
    s_mov_b64 exec, 1
    buffer_store_dword v3, v2, s[44:47], 0 offen sc1
    s_mov_b64 exec, -1
    s_branch L_fin
L_mwave:
    s_setprio 2
    s_and_b32 s60, s48, 1
    s_lshr_b32 s61, s48, 1
    v_and_b32 v10, 31, v1
    v_lshrrev_b32 v11, 5, v1
    s_lshl_b32 s74, s54, 9
    v_lshlrev_b32 v13, 4, v10
    s_mul_i32 s73, s51, 57344
    s_lshl_b32 s58, s54, 7
    s_add_u32 s73, s73, s58
    s_sub_u32 s73, s73, 2688
    s_cmp_eq_u32 s51, 0
    s_cselect_b32 s73, 0x40000000, s73
    v_lshlrev_b32 v12, 2, v10
    s_waitcnt lgkmcnt(0)
    s_load_dword s78, s[44:45], 0
    buffer_load_dwordx4 v[40:43], v13, s[16:19], s74 offen
    s_cmp_lg_u32 s48, 0
    s_cbranch_scc1 L_nohalo
    buffer_load_dword v17, v12, s[8:11], s73 offen offset:0
    buffer_load_dword v18, v12, s[8:11], s73 offen offset:896
    buffer_load_dword v19, v12, s[8:11], s73 offen offset:1792
L_nohalo:
    v_bfe_u32 v14, v10, 1, 3
    v_xor_b32 v14, v14, v11
    s_lshl_b32 s58, s60, 13
    v_lshlrev_b32 v48, 7, v10
    v_add_u32 v48, s58, v48
    v_xor_b32 v49, 0, v14
    v_lshl_add_u32 v4, v49, 4, v48
    v_add_u32 v76, 0x10000, v4
    v_xor_b32 v49, 2, v14
    v_lshl_add_u32 v5, v49, 4, v48
    v_add_u32 v77, 0x10000, v5
    v_xor_b32 v49, 4, v14
    v_lshl_add_u32 v6, v49, 4, v48
    v_add_u32 v78, 0x10000, v6
    v_xor_b32 v49, 6, v14
    v_lshl_add_u32 v7, v49, 4, v48
    v_add_u32 v79, 0x10000, v7
    s_lshl_b32 s58, s48, 11
    s_add_u32 s58, s58, 48768
    v_lshl_add_u32 v12, v11, 10, v12
    v_add_u32 v12, s58, v12
    v_lshlrev_b32 v16, 6, v10
    v_lshlrev_b32 v48, 4, v11
    v_sub_u32 v16, v16, v48
    s_add_u32 s58, s58, 8592
    v_add_u32 v16, s58, v16
    v_bfe_u32 v14, v1, 2, 2
    v_lshl_add_u32 v48, v11, 3, v14
    v_lshlrev_b32 v48, 7, v48
    v_lshrrev_b32 v14, 1, v14
    v_xor_b32 v14, s61, v14
    v_lshl_add_u32 v48, v14, 6, v48
    v_bfe_u32 v14, v1, 4, 1
    v_lshl_add_u32 v48, v14, 5, v48
    v_and_b32 v14, 3, v1
    v_lshl_add_u32 v8, v14, 3, v48
    v_add_u32 v9, 0x10000, v8
    v_add_u32 v10, 0x20000, v8
    v_lshlrev_b32 v2, 4, v1
    s_lshl_b32 s58, s48, 2
    s_add_u32 s58, s58, 151040
    v_mov_b32 v3, s58
    v_and_b32 v0, 3, v1
    v_lshlrev_b32 v0, 2, v0
    v_add_u32 v0, 151040, v0
    s_lshl_b32 s3, s53, 1
    s_add_u32 s3, s3, s54
    s_cmp_ge_u32 s3, 7
    s_cselect_b32 s58, 7, 0
    s_sub_u32 s3, s3, s58
    s_lshl_b32 s67, s49, 1
    s_add_u32 s67, s67, s60
    s_lshl_b32 s62, s67, 10
    s_add_u32 s62, s62, 65536
    s_lshl_b32 s63, s50, 11
    s_lshl_b32 s58, s61, 9
    s_add_u32 s63, s63, s58
    s_add_u32 s63, s63, 98304
    s_add_u32 s64, s63, 28672
    s_lshl_b32 s66, s50, 1
    s_add_u32 s66, s66, s61
    s_mul_i32 s68, s67, 56
    s_add_u32 s68, s68, s66
    s_lshl_b32 s68, s68, 11
    s_add_u32 s68, s68, 4194304
    s_add_u32 s69, s68, 57344
    s_add_u32 s70, s68, 3670016
    s_add_u32 s71, s69, 3670016
    s_mul_i32 s58, s66, 37
    s_lshr_b32 s58, s58, 8
    s_add_u32 s66, s66, s58
    s_lshl_b32 s72, s67, 7
    s_lshl_b32 s66, s66, 2
    s_add_u32 s72, s72, s66
    s_add_u32 s72, s72, 16384
    s_add_u32 s73, s72, 4096
    s_cmp_eq_u32 s48, 0
    s_cselect_b32 s74, -1, 0
    s_mov_b32 s75, 0
    s_waitcnt lgkmcnt(0)
    s_mul_i32 s77, s78, 0x9E3779B1
    s_add_u32 s77, s77, 0x7F4A7C15
    s_lshr_b32 s78, s77, 15
    s_xor_b32 s78, s78, s77
    s_and_b32 s78, s78, 0xBFFFBFFF
    s_mov_b32 s79, s78
    v_mov_b32 v15, s78
    s_waitcnt lgkmcnt(0)
    s_barrier
    ds_read_b64_tr_b16 v[80:81], v8 offset:16384
    ds_read_b64_tr_b16 v[82:83], v8 offset:16896
    ds_read_b128 v[84:87], v4 offset:0
    ds_read_b128 v[88:91], v4 offset:4096
    ds_read_b64_tr_b16 v[92:93], v8 offset:24576
    ds_read_b64_tr_b16 v[94:95], v8 offset:25088
    ds_read_b64_tr_b16 v[96:97], v8 offset:32768
    ds_read_b64_tr_b16 v[98:99], v8 offset:33280
    ds_read_b64_tr_b16 v[100:101], v8 offset:40960
    ds_read_b64_tr_b16 v[102:103], v8 offset:41472
    ds_read_b64_tr_b16 v[104:105], v8 offset:18432
    ds_read_b64_tr_b16 v[106:107], v8 offset:18944
    s_waitcnt lgkmcnt(9)
    v_mfma_f32_32x32x16_bf16 v[128:143], v[80:83], v[84:87], 0
    ds_read_b128 v[108:111], v5 offset:0
    ds_read_b128 v[112:115], v5 offset:4096
    s_waitcnt lgkmcnt(10)
    v_mfma_f32_32x32x16_bf16 v[144:159], v[80:83], v[88:91], 0
    ds_read_b64_tr_b16 v[116:117], v8 offset:26624
    ds_read_b64_tr_b16 v[118:119], v8 offset:27136
    s_waitcnt lgkmcnt(10)
    v_mfma_f32_32x32x16_bf16 v[160:175], v[92:95], v[84:87], 0
    ds_read_b64_tr_b16 v[120:121], v8 offset:34816
    ds_read_b64_tr_b16 v[122:123], v8 offset:35328
    v_mfma_f32_32x32x16_bf16 v[176:191], v[92:95], v[88:91], 0
    ds_read_b64_tr_b16 v[124:125], v8 offset:43008
    ds_read_b64_tr_b16 v[126:127], v8 offset:43520
    s_waitcnt lgkmcnt(6)
    v_mfma_f32_32x32x16_bf16 v[192:207], v[96:99], v[84:87], 0
    ds_read_b64_tr_b16 v[80:81], v8 offset:20480
    ds_read_b64_tr_b16 v[82:83], v8 offset:20992
    v_mfma_f32_32x32x16_bf16 v[208:223], v[96:99], v[88:91], 0
    ds_read_b128 v[92:95], v6 offset:0
    ds_read_b128 v[96:99], v6 offset:4096
    v_mfma_f32_32x32x16_bf16 v[224:239], v[100:103], v[84:87], 0
    ds_read_b64_tr_b16 v[84:85], v8 offset:28672
    ds_read_b64_tr_b16 v[86:87], v8 offset:29184
    v_mfma_f32_32x32x16_bf16 v[240:255], v[100:103], v[88:91], 0
    ds_read_b64_tr_b16 v[100:101], v8 offset:36864
    ds_read_b64_tr_b16 v[102:103], v8 offset:37376
    v_mfma_f32_32x32x16_bf16 v[128:143], v[104:107], v[108:111], v[128:143]
    ds_read_b64_tr_b16 v[88:89], v8 offset:45056
    ds_read_b64_tr_b16 v[90:91], v8 offset:45568
    v_mfma_f32_32x32x16_bf16 v[144:159], v[104:107], v[112:115], v[144:159]
    ds_read_b64_tr_b16 v[104:105], v8 offset:22528
    ds_read_b64_tr_b16 v[106:107], v8 offset:23040
    s_waitcnt lgkmcnt(6)
    v_mfma_f32_32x32x16_bf16 v[160:175], v[116:119], v[108:111], v[160:175]
    v_mfma_f32_32x32x16_bf16 v[176:191], v[116:119], v[112:115], v[176:191]
    ds_read_b128 v[116:119], v7 offset:0
    v_mfma_f32_32x32x16_bf16 v[192:207], v[120:123], v[108:111], v[192:207]
    v_mfma_f32_32x32x16_bf16 v[208:223], v[120:123], v[112:115], v[208:223]
    ds_read_b128 v[120:123], v7 offset:4096
    v_mfma_f32_32x32x16_bf16 v[224:239], v[124:127], v[108:111], v[224:239]
    ds_read_b64_tr_b16 v[108:109], v8 offset:30720
    ds_read_b64_tr_b16 v[110:111], v8 offset:31232
    v_mfma_f32_32x32x16_bf16 v[240:255], v[124:127], v[112:115], v[240:255]
    ds_read_b64_tr_b16 v[124:125], v8 offset:38912
    ds_read_b64_tr_b16 v[126:127], v8 offset:39424
    v_mfma_f32_32x32x16_bf16 v[128:143], v[80:83], v[92:95], v[128:143]
    ds_read_b64_tr_b16 v[112:113], v8 offset:47104
    ds_read_b64_tr_b16 v[114:115], v8 offset:47616
    v_mfma_f32_32x32x16_bf16 v[144:159], v[80:83], v[96:99], v[144:159]
    v_mfma_f32_32x32x16_bf16 v[160:175], v[84:87], v[92:95], v[160:175]
    v_mfma_f32_32x32x16_bf16 v[176:191], v[84:87], v[96:99], v[176:191]
    s_waitcnt lgkmcnt(0)
    v_mfma_f32_32x32x16_bf16 v[192:207], v[100:103], v[92:95], v[192:207]
    v_mfma_f32_32x32x16_bf16 v[208:223], v[100:103], v[96:99], v[208:223]
    v_mfma_f32_32x32x16_bf16 v[224:239], v[88:91], v[92:95], v[224:239]
    v_mfma_f32_32x32x16_bf16 v[240:255], v[88:91], v[96:99], v[240:255]
    v_mfma_f32_32x32x16_bf16 v[128:143], v[104:107], v[116:119], v[128:143]
    s_waitcnt lgkmcnt(0)
    s_barrier
    ds_read_b64_tr_b16 v[80:81], v10 offset:0
    ds_read_b64_tr_b16 v[82:83], v10 offset:512
    ds_read_b128 v[84:87], v76 offset:49152
    ds_read_b32 v20, v12 offset:0
    ds_read_b32 v21, v12 offset:128
    ds_read_b32 v22, v12 offset:256
    ds_read_b32 v23, v12 offset:384
    ds_read_b32 v24, v12 offset:512
    ds_read_b32 v25, v12 offset:640
    v_mfma_f32_32x32x16_bf16 v[144:159], v[104:107], v[120:123], v[144:159]
    ds_read_b128 v[100:103], v76 offset:53248
    ds_read_b64_tr_b16 v[92:93], v10 offset:8192
    ds_read_b64_tr_b16 v[94:95], v10 offset:8704
    ds_read_b32 v26, v12 offset:768
    ds_read_b32 v27, v12 offset:896
    ds_read_b32 v28, v12 offset:1024
    ds_read_b32 v29, v12 offset:1152
    ds_read_b32 v30, v12 offset:1280
    ds_read_b32 v32, v12 offset:8576
    v_mfma_f32_32x32x16_bf16 v[160:175], v[108:111], v[116:119], v[160:175]
    ds_read_b64_tr_b16 v[88:89], v10 offset:16384
    ds_read_b64_tr_b16 v[90:91], v10 offset:16896
    ds_read_b32 v33, v12 offset:8704
    ds_read_b32 v34, v12 offset:8832
    ds_read_b32 v35, v12 offset:8960
    ds_read_b32 v36, v12 offset:9088
    ds_read_b32 v37, v12 offset:9216
    ds_read_b32 v38, v12 offset:9344
    ds_read_b32 v39, v12 offset:9472
    v_mfma_f32_32x32x16_bf16 v[176:191], v[108:111], v[120:123], v[176:191]
    ds_read_b64_tr_b16 v[96:97], v10 offset:24576
    ds_read_b64_tr_b16 v[98:99], v10 offset:25088
    v_mfma_f32_32x32x16_bf16 v[192:207], v[124:127], v[116:119], v[192:207]
    ds_read_b64_tr_b16 v[104:105], v10 offset:2048
    ds_read_b64_tr_b16 v[106:107], v10 offset:2560
    v_mfma_f32_32x32x16_bf16 v[208:223], v[124:127], v[120:123], v[208:223]
    ds_read_b128 v[108:111], v77 offset:49152
    ds_read_b128 v[124:127], v77 offset:53248
    s_waitcnt vmcnt(0) lgkmcnt(0)
    v_cndmask_b32 v20, v20, v17, s[74:75]
    v_cndmask_b32 v21, v21, v18, s[74:75]
    v_cndmask_b32 v22, v22, v19, s[74:75]
    v_lshlrev_b32 v44, 16, v20
    v_lshlrev_b32 v45, 16, v21
    v_lshlrev_b32 v46, 16, v22
    v_mfma_f32_32x32x16_bf16 v[224:239], v[112:115], v[116:119], v[224:239]
    ds_read_b64_tr_b16 v[116:117], v10 offset:10240
    ds_read_b64_tr_b16 v[118:119], v10 offset:10752
    v_lshlrev_b32 v47, 16, v23
    v_lshlrev_b32 v48, 16, v24
    v_lshlrev_b32 v49, 16, v25
    v_lshlrev_b32 v50, 16, v26
    v_lshlrev_b32 v51, 16, v27
    v_lshlrev_b32 v52, 16, v28
    v_lshlrev_b32 v53, 16, v29
    v_mfma_f32_32x32x16_bf16 v[240:255], v[112:115], v[120:123], v[240:255]
    ds_read_b64_tr_b16 v[112:113], v10 offset:18432
    ds_read_b64_tr_b16 v[114:115], v10 offset:18944
    v_lshlrev_b32 v54, 16, v30
    v_lshlrev_b32 v55, 16, v40
    v_and_b32 v56, 0xffff0000, v40
    v_lshlrev_b32 v57, 16, v41
    v_and_b32 v58, 0xffff0000, v41
    v_mul_f32 v60, v58, v44
    v_mul_f32 v61, v58, v45
    v_mfma_f32_32x32x16_bf16 v[128:143], v[80:83], v[84:87], v[128:143]
    ds_read_b64_tr_b16 v[120:121], v10 offset:26624
    ds_read_b64_tr_b16 v[122:123], v10 offset:27136
    v_mul_f32 v62, v58, v46
    v_mul_f32 v63, v58, v47
    v_mul_f32 v64, v58, v48
    v_mul_f32 v65, v58, v49
    v_mul_f32 v66, v58, v50
    v_mul_f32 v67, v58, v51
    v_fmac_f32 v60, v57, v45
    v_mfma_f32_32x32x16_bf16 v[144:159], v[80:83], v[100:103], v[144:159]
    ds_read_b64_tr_b16 v[80:81], v10 offset:4096
    ds_read_b64_tr_b16 v[82:83], v10 offset:4608
    v_fmac_f32 v61, v57, v46
    v_fmac_f32 v62, v57, v47
    v_fmac_f32 v63, v57, v48
    v_fmac_f32 v64, v57, v49
    v_fmac_f32 v65, v57, v50
    v_fmac_f32 v66, v57, v51
    v_fmac_f32 v67, v57, v52
    v_mfma_f32_32x32x16_bf16 v[160:175], v[92:95], v[84:87], v[160:175]
    v_fmac_f32 v60, v56, v46
    v_fmac_f32 v61, v56, v47
    v_fmac_f32 v62, v56, v48
    v_fmac_f32 v63, v56, v49
    v_fmac_f32 v64, v56, v50
    v_fmac_f32 v65, v56, v51
    v_fmac_f32 v66, v56, v52
    v_fmac_f32 v67, v56, v53
    v_fmac_f32 v60, v55, v47
    v_mfma_f32_32x32x16_bf16 v[176:191], v[92:95], v[100:103], v[176:191]
    ds_read_b128 v[92:95], v78 offset:49152
    v_fmac_f32 v61, v55, v48
    v_fmac_f32 v62, v55, v49
    v_fmac_f32 v63, v55, v50
    v_fmac_f32 v64, v55, v51
    v_fmac_f32 v65, v55, v52
    v_fmac_f32 v66, v55, v53
    v_fmac_f32 v67, v55, v54
    v_lshlrev_b32 v44, 16, v32
    v_mfma_f32_32x32x16_bf16 v[192:207], v[88:91], v[84:87], v[192:207]
    v_lshlrev_b32 v45, 16, v33
    v_lshlrev_b32 v46, 16, v34
    v_lshlrev_b32 v47, 16, v35
    v_lshlrev_b32 v48, 16, v36
    v_lshlrev_b32 v49, 16, v37
    v_lshlrev_b32 v50, 16, v38
    v_lshlrev_b32 v51, 16, v39
    v_mul_f32 v60, v60, v44
    v_mul_f32 v61, v61, v45
    v_mfma_f32_32x32x16_bf16 v[208:223], v[88:91], v[100:103], v[208:223]
    ds_read_b128 v[88:91], v78 offset:53248
    v_mul_f32 v62, v62, v46
    v_mul_f32 v63, v63, v47
    v_mul_f32 v64, v64, v48
    v_mul_f32 v65, v65, v49
    v_mul_f32 v66, v66, v50
    v_mul_f32 v67, v67, v51
    v_cvt_pk_bf16_f32 v68, v67, v66
    v_cvt_pk_bf16_f32 v69, v65, v64
    v_mfma_f32_32x32x16_bf16 v[224:239], v[96:99], v[84:87], v[224:239]
    ds_read_b64_tr_b16 v[84:85], v10 offset:12288
    ds_read_b64_tr_b16 v[86:87], v10 offset:12800
    v_cvt_pk_bf16_f32 v70, v63, v62
    v_cvt_pk_bf16_f32 v71, v61, v60
    v_and_b32 v44, 0xffff0000, v20
    v_and_b32 v45, 0xffff0000, v21
    v_and_b32 v46, 0xffff0000, v22
    v_and_b32 v47, 0xffff0000, v23
    v_and_b32 v48, 0xffff0000, v24
    v_mfma_f32_32x32x16_bf16 v[240:255], v[96:99], v[100:103], v[240:255]
    ds_read_b64_tr_b16 v[96:97], v10 offset:20480
    ds_read_b64_tr_b16 v[98:99], v10 offset:20992
    v_and_b32 v49, 0xffff0000, v25
    v_and_b32 v50, 0xffff0000, v26
    v_and_b32 v51, 0xffff0000, v27
    v_and_b32 v52, 0xffff0000, v28
    v_and_b32 v53, 0xffff0000, v29
    v_and_b32 v54, 0xffff0000, v30
    v_lshlrev_b32 v55, 16, v42
    v_mfma_f32_32x32x16_bf16 v[128:143], v[104:107], v[108:111], v[128:143]
    ds_read_b64_tr_b16 v[100:101], v10 offset:28672
    ds_read_b64_tr_b16 v[102:103], v10 offset:29184
    v_and_b32 v56, 0xffff0000, v42
    v_lshlrev_b32 v57, 16, v43
    v_and_b32 v58, 0xffff0000, v43
    v_mul_f32 v60, v58, v44
    v_mul_f32 v61, v58, v45
    v_mul_f32 v62, v58, v46
    v_mul_f32 v63, v58, v47
    v_mfma_f32_32x32x16_bf16 v[144:159], v[104:107], v[124:127], v[144:159]
    ds_read_b64_tr_b16 v[104:105], v10 offset:6144
    ds_read_b64_tr_b16 v[106:107], v10 offset:6656
    v_mul_f32 v64, v58, v48
    v_mul_f32 v65, v58, v49
    v_mul_f32 v66, v58, v50
    v_mul_f32 v67, v58, v51
    v_fmac_f32 v60, v57, v45
    v_fmac_f32 v61, v57, v46
    v_fmac_f32 v62, v57, v47
    s_waitcnt lgkmcnt(6)
    v_mfma_f32_32x32x16_bf16 v[160:175], v[116:119], v[108:111], v[160:175]
    v_fmac_f32 v63, v57, v48
    v_fmac_f32 v64, v57, v49
    v_fmac_f32 v65, v57, v50
    v_fmac_f32 v66, v57, v51
    v_fmac_f32 v67, v57, v52
    v_fmac_f32 v60, v56, v46
    v_fmac_f32 v61, v56, v47
    v_fmac_f32 v62, v56, v48
    v_fmac_f32 v63, v56, v49
    v_mfma_f32_32x32x16_bf16 v[176:191], v[116:119], v[124:127], v[176:191]
    ds_read_b128 v[116:119], v79 offset:49152
    v_fmac_f32 v64, v56, v50
    v_fmac_f32 v65, v56, v51
    v_fmac_f32 v66, v56, v52
    v_fmac_f32 v67, v56, v53
    v_fmac_f32 v60, v55, v47
    v_fmac_f32 v61, v55, v48
    v_fmac_f32 v62, v55, v49
    v_fmac_f32 v63, v55, v50
    v_mfma_f32_32x32x16_bf16 v[192:207], v[112:115], v[108:111], v[192:207]
    v_fmac_f32 v64, v55, v51
    v_fmac_f32 v65, v55, v52
    v_fmac_f32 v66, v55, v53
    v_fmac_f32 v67, v55, v54
    v_and_b32 v44, 0xffff0000, v32
    v_and_b32 v45, 0xffff0000, v33
    v_and_b32 v46, 0xffff0000, v34
    v_and_b32 v47, 0xffff0000, v35
    v_and_b32 v48, 0xffff0000, v36
    v_mfma_f32_32x32x16_bf16 v[208:223], v[112:115], v[124:127], v[208:223]
    ds_read_b128 v[112:115], v79 offset:53248
    v_and_b32 v49, 0xffff0000, v37
    v_and_b32 v50, 0xffff0000, v38
    v_and_b32 v51, 0xffff0000, v39
    v_mul_f32 v60, v60, v44
    v_mul_f32 v61, v61, v45
    v_mul_f32 v62, v62, v46
    v_mul_f32 v63, v63, v47
    v_mul_f32 v64, v64, v48
    v_mfma_f32_32x32x16_bf16 v[224:239], v[120:123], v[108:111], v[224:239]
    ds_read_b64_tr_b16 v[108:109], v10 offset:14336
    ds_read_b64_tr_b16 v[110:111], v10 offset:14848
    v_mul_f32 v65, v65, v49
    v_mul_f32 v66, v66, v50
    v_mul_f32 v67, v67, v51
    v_cvt_pk_bf16_f32 v72, v67, v66
    v_cvt_pk_bf16_f32 v73, v65, v64
    v_cvt_pk_bf16_f32 v74, v63, v62
    v_cvt_pk_bf16_f32 v75, v61, v60
    v_mfma_f32_32x32x16_bf16 v[240:255], v[120:123], v[124:127], v[240:255]
    ds_read_b64_tr_b16 v[120:121], v10 offset:22528
    ds_read_b64_tr_b16 v[122:123], v10 offset:23040
    ds_write_b128 v16, v[68:71] offset:0
    ds_write_b128 v16, v[72:75] offset:32
    v_mfma_f32_32x32x16_bf16 v[128:143], v[80:83], v[92:95], v[128:143]
    ds_read_b64_tr_b16 v[124:125], v10 offset:30720
    ds_read_b64_tr_b16 v[126:127], v10 offset:31232
    v_mfma_f32_32x32x16_bf16 v[144:159], v[80:83], v[88:91], v[144:159]
    v_mfma_f32_32x32x16_bf16 v[160:175], v[84:87], v[92:95], v[160:175]
    v_mfma_f32_32x32x16_bf16 v[176:191], v[84:87], v[88:91], v[176:191]
    s_waitcnt lgkmcnt(0)
    v_mfma_f32_32x32x16_bf16 v[192:207], v[96:99], v[92:95], v[192:207]
    v_mfma_f32_32x32x16_bf16 v[208:223], v[96:99], v[88:91], v[208:223]
    v_mfma_f32_32x32x16_bf16 v[224:239], v[100:103], v[92:95], v[224:239]
    v_mfma_f32_32x32x16_bf16 v[240:255], v[100:103], v[88:91], v[240:255]
    v_mfma_f32_32x32x16_bf16 v[128:143], v[104:107], v[116:119], v[128:143]
    s_waitcnt lgkmcnt(0)
    s_barrier
    ds_read_b64_tr_b16 v[80:81], v9 offset:16384
    ds_read_b64_tr_b16 v[82:83], v9 offset:16896
    ds_read_b128 v[84:87], v76 offset:0
    v_mfma_f32_32x32x16_bf16 v[144:159], v[104:107], v[112:115], v[144:159]
    ds_read_b128 v[96:99], v76 offset:4096
    ds_read_b64_tr_b16 v[92:93], v9 offset:24576
    ds_read_b64_tr_b16 v[94:95], v9 offset:25088
    v_mfma_f32_32x32x16_bf16 v[160:175], v[108:111], v[116:119], v[160:175]
    ds_read_b64_tr_b16 v[100:101], v9 offset:32768
    ds_read_b64_tr_b16 v[102:103], v9 offset:33280
    v_mfma_f32_32x32x16_bf16 v[176:191], v[108:111], v[112:115], v[176:191]
    ds_read_b64_tr_b16 v[88:89], v9 offset:40960
    ds_read_b64_tr_b16 v[90:91], v9 offset:41472
    v_mfma_f32_32x32x16_bf16 v[192:207], v[120:123], v[116:119], v[192:207]
    ds_read_b64_tr_b16 v[104:105], v9 offset:18432
    ds_read_b64_tr_b16 v[106:107], v9 offset:18944
    v_mfma_f32_32x32x16_bf16 v[208:223], v[120:123], v[112:115], v[208:223]
    ds_read_b128 v[108:111], v77 offset:0
    ds_read_b128 v[120:123], v77 offset:4096
    v_mfma_f32_32x32x16_bf16 v[224:239], v[124:127], v[116:119], v[224:239]
    ds_read_b64_tr_b16 v[116:117], v9 offset:26624
    ds_read_b64_tr_b16 v[118:119], v9 offset:27136
    v_mfma_f32_32x32x16_bf16 v[240:255], v[124:127], v[112:115], v[240:255]
    ds_read_b64_tr_b16 v[124:125], v9 offset:34816
    ds_read_b64_tr_b16 v[126:127], v9 offset:35328
    s_waitcnt lgkmcnt(6)
    v_mfma_f32_32x32x16_bf16 v[128:143], v[80:83], v[84:87], v[128:143]
    ds_read_b64_tr_b16 v[112:113], v9 offset:43008
    ds_read_b64_tr_b16 v[114:115], v9 offset:43520
    v_mfma_f32_32x32x16_bf16 v[144:159], v[80:83], v[96:99], v[144:159]
    ds_read_b64_tr_b16 v[80:81], v9 offset:20480
    ds_read_b64_tr_b16 v[82:83], v9 offset:20992
    v_mfma_f32_32x32x16_bf16 v[160:175], v[92:95], v[84:87], v[160:175]
    v_mfma_f32_32x32x16_bf16 v[176:191], v[92:95], v[96:99], v[176:191]
    ds_read_b128 v[92:95], v78 offset:0
    v_mfma_f32_32x32x16_bf16 v[192:207], v[100:103], v[84:87], v[192:207]
    v_mfma_f32_32x32x16_bf16 v[208:223], v[100:103], v[96:99], v[208:223]
    ds_read_b128 v[100:103], v78 offset:4096
    v_mfma_f32_32x32x16_bf16 v[224:239], v[88:91], v[84:87], v[224:239]
    ds_read_b64_tr_b16 v[84:85], v9 offset:28672
    ds_read_b64_tr_b16 v[86:87], v9 offset:29184
    v_mfma_f32_32x32x16_bf16 v[240:255], v[88:91], v[96:99], v[240:255]
    ds_read_b64_tr_b16 v[88:89], v9 offset:36864
    ds_read_b64_tr_b16 v[90:91], v9 offset:37376
    s_waitcnt lgkmcnt(5)
    v_mfma_f32_32x32x16_bf16 v[128:143], v[104:107], v[108:111], v[128:143]
    ds_read_b64_tr_b16 v[96:97], v9 offset:45056
    ds_read_b64_tr_b16 v[98:99], v9 offset:45568
    v_mfma_f32_32x32x16_bf16 v[144:159], v[104:107], v[120:123], v[144:159]
    ds_read_b64_tr_b16 v[104:105], v9 offset:22528
    ds_read_b64_tr_b16 v[106:107], v9 offset:23040
    v_mfma_f32_32x32x16_bf16 v[160:175], v[116:119], v[108:111], v[160:175]
    v_mfma_f32_32x32x16_bf16 v[176:191], v[116:119], v[120:123], v[176:191]
    ds_read_b128 v[116:119], v79 offset:0
    v_mfma_f32_32x32x16_bf16 v[192:207], v[124:127], v[108:111], v[192:207]
    v_mfma_f32_32x32x16_bf16 v[208:223], v[124:127], v[120:123], v[208:223]
    ds_read_b128 v[124:127], v79 offset:4096
    v_mfma_f32_32x32x16_bf16 v[224:239], v[112:115], v[108:111], v[224:239]
    ds_read_b64_tr_b16 v[108:109], v9 offset:30720
    ds_read_b64_tr_b16 v[110:111], v9 offset:31232
    v_mfma_f32_32x32x16_bf16 v[240:255], v[112:115], v[120:123], v[240:255]
    ds_read_b64_tr_b16 v[112:113], v9 offset:38912
    ds_read_b64_tr_b16 v[114:115], v9 offset:39424
    v_mfma_f32_32x32x16_bf16 v[128:143], v[80:83], v[92:95], v[128:143]
    ds_read_b64_tr_b16 v[120:121], v9 offset:47104
    ds_read_b64_tr_b16 v[122:123], v9 offset:47616
    s_waitcnt lgkmcnt(6)
    v_mfma_f32_32x32x16_bf16 v[144:159], v[80:83], v[100:103], v[144:159]
    v_mfma_f32_32x32x16_bf16 v[160:175], v[84:87], v[92:95], v[160:175]
    v_mfma_f32_32x32x16_bf16 v[176:191], v[84:87], v[100:103], v[176:191]
    v_mfma_f32_32x32x16_bf16 v[192:207], v[88:91], v[92:95], v[192:207]
    v_mfma_f32_32x32x16_bf16 v[208:223], v[88:91], v[100:103], v[208:223]
    v_mfma_f32_32x32x16_bf16 v[224:239], v[96:99], v[92:95], v[224:239]
    v_mfma_f32_32x32x16_bf16 v[240:255], v[96:99], v[100:103], v[240:255]
    v_mfma_f32_32x32x16_bf16 v[128:143], v[104:107], v[116:119], v[128:143]
    s_waitcnt lgkmcnt(0)
    s_barrier
    ds_read_b64_tr_b16 v[80:81], v8 offset:16384
    ds_read_b64_tr_b16 v[82:83], v8 offset:16896
    ds_read_b128 v[84:87], v4 offset:0
    v_mov_b32 v66, 0
    v_mov_b32 v67, 0
    v_mov_b32 v70, 0
    v_mfma_f32_32x32x16_bf16 v[144:159], v[104:107], v[124:127], v[144:159]
    ds_read_b128 v[88:91], v4 offset:4096
    ds_read_b64_tr_b16 v[92:93], v8 offset:24576
    ds_read_b64_tr_b16 v[94:95], v8 offset:25088
    v_mov_b32 v71, 0
    v_mfma_f32_32x32x16_bf16 v[160:175], v[108:111], v[116:119], v[160:175]
    ds_read_b64_tr_b16 v[96:97], v8 offset:32768
    ds_read_b64_tr_b16 v[98:99], v8 offset:33280
    v_mfma_f32_32x32x16_bf16 v[176:191], v[108:111], v[124:127], v[176:191]
    ds_read_b64_tr_b16 v[100:101], v8 offset:40960
    ds_read_b64_tr_b16 v[102:103], v8 offset:41472
    v_mfma_f32_32x32x16_bf16 v[192:207], v[112:115], v[116:119], v[192:207]
    ds_read_b64_tr_b16 v[104:105], v8 offset:18432
    ds_read_b64_tr_b16 v[106:107], v8 offset:18944
    v_mfma_f32_32x32x16_bf16 v[208:223], v[112:115], v[124:127], v[208:223]
    ds_read_b128 v[108:111], v5 offset:0
    ds_read_b128 v[112:115], v5 offset:4096
    v_mfma_f32_32x32x16_bf16 v[224:239], v[120:123], v[116:119], v[224:239]
    ds_read_b64_tr_b16 v[116:117], v8 offset:26624
    ds_read_b64_tr_b16 v[118:119], v8 offset:27136
    v_mfma_f32_32x32x16_bf16 v[240:255], v[120:123], v[124:127], v[240:255]
    ds_read_b64_tr_b16 v[120:121], v8 offset:34816
    ds_read_b64_tr_b16 v[122:123], v8 offset:35328
    s_waitcnt lgkmcnt(6)
    v_mfma_f32_32x32x16_bf16 v[128:143], v[80:83], v[84:87], v[128:143]
    ds_read_b64_tr_b16 v[124:125], v8 offset:43008
    ds_read_b64_tr_b16 v[126:127], v8 offset:43520
    v_mfma_f32_32x32x16_bf16 v[144:159], v[80:83], v[88:91], v[144:159]
    ds_read_b64_tr_b16 v[80:81], v8 offset:20480
    ds_read_b64_tr_b16 v[82:83], v8 offset:20992
    v_mfma_f32_32x32x16_bf16 v[160:175], v[92:95], v[84:87], v[160:175]
    v_mfma_f32_32x32x16_bf16 v[176:191], v[92:95], v[88:91], v[176:191]
    ds_read_b128 v[92:95], v6 offset:0
    v_mfma_f32_32x32x16_bf16 v[192:207], v[96:99], v[84:87], v[192:207]
    v_mfma_f32_32x32x16_bf16 v[208:223], v[96:99], v[88:91], v[208:223]
    ds_read_b128 v[96:99], v6 offset:4096
    v_mfma_f32_32x32x16_bf16 v[224:239], v[100:103], v[84:87], v[224:239]
    ds_read_b64_tr_b16 v[84:85], v8 offset:28672
    ds_read_b64_tr_b16 v[86:87], v8 offset:29184
    v_mfma_f32_32x32x16_bf16 v[240:255], v[100:103], v[88:91], v[240:255]
    ds_read_b64_tr_b16 v[100:101], v8 offset:36864
    ds_read_b64_tr_b16 v[102:103], v8 offset:37376
    s_waitcnt lgkmcnt(5)
    v_mfma_f32_32x32x16_bf16 v[128:143], v[104:107], v[108:111], v[128:143]
    ds_read_b64_tr_b16 v[88:89], v8 offset:45056
    ds_read_b64_tr_b16 v[90:91], v8 offset:45568
    v_mfma_f32_32x32x16_bf16 v[144:159], v[104:107], v[112:115], v[144:159]
    ds_read_b64_tr_b16 v[104:105], v8 offset:22528
    ds_read_b64_tr_b16 v[106:107], v8 offset:23040
    v_mfma_f32_32x32x16_bf16 v[160:175], v[116:119], v[108:111], v[160:175]
    v_mfma_f32_32x32x16_bf16 v[176:191], v[116:119], v[112:115], v[176:191]
    ds_read_b128 v[116:119], v7 offset:0
    v_mfma_f32_32x32x16_bf16 v[192:207], v[120:123], v[108:111], v[192:207]
    v_mfma_f32_32x32x16_bf16 v[208:223], v[120:123], v[112:115], v[208:223]
    ds_read_b128 v[120:123], v7 offset:4096
    v_mfma_f32_32x32x16_bf16 v[224:239], v[124:127], v[108:111], v[224:239]
    ds_read_b64_tr_b16 v[108:109], v8 offset:30720
    ds_read_b64_tr_b16 v[110:111], v8 offset:31232
    v_mfma_f32_32x32x16_bf16 v[240:255], v[124:127], v[112:115], v[240:255]
    ds_read_b64_tr_b16 v[124:125], v8 offset:38912
    ds_read_b64_tr_b16 v[126:127], v8 offset:39424
    v_mfma_f32_32x32x16_bf16 v[128:143], v[80:83], v[92:95], v[128:143]
    ds_read_b64_tr_b16 v[112:113], v8 offset:47104
    ds_read_b64_tr_b16 v[114:115], v8 offset:47616
    s_waitcnt lgkmcnt(6)
    v_mfma_f32_32x32x16_bf16 v[144:159], v[80:83], v[96:99], v[144:159]
    v_mfma_f32_32x32x16_bf16 v[160:175], v[84:87], v[92:95], v[160:175]
    v_mfma_f32_32x32x16_bf16 v[176:191], v[84:87], v[96:99], v[176:191]
    v_mfma_f32_32x32x16_bf16 v[192:207], v[100:103], v[92:95], v[192:207]
    v_mfma_f32_32x32x16_bf16 v[208:223], v[100:103], v[96:99], v[208:223]
    v_mfma_f32_32x32x16_bf16 v[224:239], v[88:91], v[92:95], v[224:239]
    v_mfma_f32_32x32x16_bf16 v[240:255], v[88:91], v[96:99], v[240:255]
    v_mfma_f32_32x32x16_bf16 v[128:143], v[104:107], v[116:119], v[128:143]
    s_waitcnt lgkmcnt(0)
    s_barrier
    ds_read_b64_tr_b16 v[80:81], v10 offset:0
    ds_read_b64_tr_b16 v[82:83], v10 offset:512
    ds_read_b128 v[84:87], v76 offset:49152
    v_mfma_f32_32x32x16_bf16 v[144:159], v[104:107], v[120:123], v[144:159]
    ds_read_b128 v[100:103], v76 offset:53248
    ds_read_b64_tr_b16 v[92:93], v10 offset:8192
    ds_read_b64_tr_b16 v[94:95], v10 offset:8704
    v_mfma_f32_32x32x16_bf16 v[160:175], v[108:111], v[116:119], v[160:175]
    ds_read_b64_tr_b16 v[88:89], v10 offset:16384
    ds_read_b64_tr_b16 v[90:91], v10 offset:16896
    v_mfma_f32_32x32x16_bf16 v[176:191], v[108:111], v[120:123], v[176:191]
    ds_read_b64_tr_b16 v[96:97], v10 offset:24576
    ds_read_b64_tr_b16 v[98:99], v10 offset:25088
    v_mfma_f32_32x32x16_bf16 v[192:207], v[124:127], v[116:119], v[192:207]
    ds_read_b64_tr_b16 v[104:105], v10 offset:2048
    ds_read_b64_tr_b16 v[106:107], v10 offset:2560
    v_mfma_f32_32x32x16_bf16 v[208:223], v[124:127], v[120:123], v[208:223]
    ds_read_b128 v[108:111], v77 offset:49152
    ds_read_b128 v[124:127], v77 offset:53248
    v_mfma_f32_32x32x16_bf16 v[224:239], v[112:115], v[116:119], v[224:239]
    ds_read_b64_tr_b16 v[116:117], v10 offset:10240
    ds_read_b64_tr_b16 v[118:119], v10 offset:10752
    v_mfma_f32_32x32x16_bf16 v[240:255], v[112:115], v[120:123], v[240:255]
    ds_read_b64_tr_b16 v[112:113], v10 offset:18432
    ds_read_b64_tr_b16 v[114:115], v10 offset:18944
    s_waitcnt lgkmcnt(6)
    v_mfma_f32_32x32x16_bf16 v[128:143], v[80:83], v[84:87], v[128:143]
    ds_read_b64_tr_b16 v[120:121], v10 offset:26624
    ds_read_b64_tr_b16 v[122:123], v10 offset:27136
    v_mfma_f32_32x32x16_bf16 v[144:159], v[80:83], v[100:103], v[144:159]
    ds_read_b64_tr_b16 v[80:81], v10 offset:4096
    ds_read_b64_tr_b16 v[82:83], v10 offset:4608
    v_mfma_f32_32x32x16_bf16 v[160:175], v[92:95], v[84:87], v[160:175]
    v_mfma_f32_32x32x16_bf16 v[176:191], v[92:95], v[100:103], v[176:191]
    ds_read_b128 v[92:95], v78 offset:49152
    v_mfma_f32_32x32x16_bf16 v[192:207], v[88:91], v[84:87], v[192:207]
    v_mfma_f32_32x32x16_bf16 v[208:223], v[88:91], v[100:103], v[208:223]
    ds_read_b128 v[88:91], v78 offset:53248
    v_mfma_f32_32x32x16_bf16 v[224:239], v[96:99], v[84:87], v[224:239]
    ds_read_b64_tr_b16 v[84:85], v10 offset:12288
    ds_read_b64_tr_b16 v[86:87], v10 offset:12800
    v_mfma_f32_32x32x16_bf16 v[240:255], v[96:99], v[100:103], v[240:255]
    ds_read_b64_tr_b16 v[96:97], v10 offset:20480
    ds_read_b64_tr_b16 v[98:99], v10 offset:20992
    s_waitcnt lgkmcnt(5)
    v_mfma_f32_32x32x16_bf16 v[128:143], v[104:107], v[108:111], v[128:143]
    ds_read_b64_tr_b16 v[100:101], v10 offset:28672
    ds_read_b64_tr_b16 v[102:103], v10 offset:29184
    v_mfma_f32_32x32x16_bf16 v[144:159], v[104:107], v[124:127], v[144:159]
    ds_read_b64_tr_b16 v[104:105], v10 offset:6144
    ds_read_b64_tr_b16 v[106:107], v10 offset:6656
    v_mfma_f32_32x32x16_bf16 v[160:175], v[116:119], v[108:111], v[160:175]
    v_mfma_f32_32x32x16_bf16 v[176:191], v[116:119], v[124:127], v[176:191]
    ds_read_b128 v[116:119], v79 offset:49152
    v_mfma_f32_32x32x16_bf16 v[192:207], v[112:115], v[108:111], v[192:207]
    v_mfma_f32_32x32x16_bf16 v[208:223], v[112:115], v[124:127], v[208:223]
    ds_read_b128 v[112:115], v79 offset:53248
    v_mfma_f32_32x32x16_bf16 v[224:239], v[120:123], v[108:111], v[224:239]
    ds_read_b64_tr_b16 v[108:109], v10 offset:14336
    ds_read_b64_tr_b16 v[110:111], v10 offset:14848
    v_mfma_f32_32x32x16_bf16 v[240:255], v[120:123], v[124:127], v[240:255]
    ds_read_b64_tr_b16 v[120:121], v10 offset:22528
    ds_read_b64_tr_b16 v[122:123], v10 offset:23040
    v_mfma_f32_32x32x16_bf16 v[128:143], v[80:83], v[92:95], v[128:143]
    ds_read_b64_tr_b16 v[124:125], v10 offset:30720
    ds_read_b64_tr_b16 v[126:127], v10 offset:31232
    s_waitcnt lgkmcnt(6)
    v_mfma_f32_32x32x16_bf16 v[144:159], v[80:83], v[88:91], v[144:159]
    v_mfma_f32_32x32x16_bf16 v[160:175], v[84:87], v[92:95], v[160:175]
    v_mfma_f32_32x32x16_bf16 v[176:191], v[84:87], v[88:91], v[176:191]
    v_mfma_f32_32x32x16_bf16 v[192:207], v[96:99], v[92:95], v[192:207]
    v_mfma_f32_32x32x16_bf16 v[208:223], v[96:99], v[88:91], v[208:223]
    v_mfma_f32_32x32x16_bf16 v[224:239], v[100:103], v[92:95], v[224:239]
    v_mfma_f32_32x32x16_bf16 v[240:255], v[100:103], v[88:91], v[240:255]
    v_mfma_f32_32x32x16_bf16 v[128:143], v[104:107], v[116:119], v[128:143]
    s_waitcnt lgkmcnt(0)
    s_barrier
    ds_read_b64_tr_b16 v[80:81], v9 offset:16384
    ds_read_b64_tr_b16 v[82:83], v9 offset:16896
    ds_read_b128 v[84:87], v76 offset:0
    s_lshl_b32 s58, s61, 9
    v_add_u32 v12, s58, v13
    ds_read_b128 v[48:51], v12 offset:49152
    v_mfma_f32_32x32x16_bf16 v[144:159], v[104:107], v[112:115], v[144:159]
    ds_read_b128 v[96:99], v76 offset:4096
    ds_read_b64_tr_b16 v[92:93], v9 offset:24576
    ds_read_b64_tr_b16 v[94:95], v9 offset:25088
    ds_read_b128 v[52:55], v12 offset:51200
    ds_read_b128 v[56:59], v12 offset:50176
    ds_read_b128 v[60:63], v12 offset:52224
    v_mfma_f32_32x32x16_bf16 v[160:175], v[108:111], v[116:119], v[160:175]
    ds_read_b64_tr_b16 v[100:101], v9 offset:32768
    ds_read_b64_tr_b16 v[102:103], v9 offset:33280
    s_lshl_b32 s58, s60, 10
    v_add_u32 v14, s58, v13
    ds_read_b128 v[40:43], v14 offset:53248
    ds_read_b128 v[44:47], v14 offset:53760
    v_mfma_f32_32x32x16_bf16 v[176:191], v[108:111], v[112:115], v[176:191]
    ds_read_b64_tr_b16 v[88:89], v9 offset:40960
    ds_read_b64_tr_b16 v[90:91], v9 offset:41472
    v_mfma_f32_32x32x16_bf16 v[192:207], v[120:123], v[116:119], v[192:207]
    ds_read_b64_tr_b16 v[104:105], v9 offset:18432
    ds_read_b64_tr_b16 v[106:107], v9 offset:18944
    v_mfma_f32_32x32x16_bf16 v[208:223], v[120:123], v[112:115], v[208:223]
    ds_read_b128 v[108:111], v77 offset:0
    ds_read_b128 v[120:123], v77 offset:4096
    v_mfma_f32_32x32x16_bf16 v[224:239], v[124:127], v[116:119], v[224:239]
    ds_read_b64_tr_b16 v[116:117], v9 offset:26624
    ds_read_b64_tr_b16 v[118:119], v9 offset:27136
    v_mfma_f32_32x32x16_bf16 v[240:255], v[124:127], v[112:115], v[240:255]
    ds_read_b64_tr_b16 v[124:125], v9 offset:34816
    ds_read_b64_tr_b16 v[126:127], v9 offset:35328
    s_waitcnt lgkmcnt(6)
    v_mfma_f32_32x32x16_bf16 v[128:143], v[80:83], v[84:87], v[128:143]
    ds_read_b64_tr_b16 v[112:113], v9 offset:43008
    ds_read_b64_tr_b16 v[114:115], v9 offset:43520
    v_mfma_f32_32x32x16_bf16 v[144:159], v[80:83], v[96:99], v[144:159]
    ds_read_b64_tr_b16 v[80:81], v9 offset:20480
    ds_read_b64_tr_b16 v[82:83], v9 offset:20992
    v_mfma_f32_32x32x16_bf16 v[160:175], v[92:95], v[84:87], v[160:175]
    v_mfma_f32_32x32x16_bf16 v[176:191], v[92:95], v[96:99], v[176:191]
    ds_read_b128 v[92:95], v78 offset:0
    v_mfma_f32_32x32x16_bf16 v[192:207], v[100:103], v[84:87], v[192:207]
    v_mfma_f32_32x32x16_bf16 v[208:223], v[100:103], v[96:99], v[208:223]
    ds_read_b128 v[100:103], v78 offset:4096
    v_mfma_f32_32x32x16_bf16 v[224:239], v[88:91], v[84:87], v[224:239]
    ds_read_b64_tr_b16 v[84:85], v9 offset:28672
    ds_read_b64_tr_b16 v[86:87], v9 offset:29184
    v_mfma_f32_32x32x16_bf16 v[240:255], v[88:91], v[96:99], v[240:255]
    ds_read_b64_tr_b16 v[88:89], v9 offset:36864
    ds_read_b64_tr_b16 v[90:91], v9 offset:37376
    s_waitcnt lgkmcnt(5)
    v_mfma_f32_32x32x16_bf16 v[128:143], v[104:107], v[108:111], v[128:143]
    ds_read_b64_tr_b16 v[96:97], v9 offset:45056
    ds_read_b64_tr_b16 v[98:99], v9 offset:45568
    v_mfma_f32_32x32x16_bf16 v[144:159], v[104:107], v[120:123], v[144:159]
    ds_read_b64_tr_b16 v[104:105], v9 offset:22528
    ds_read_b64_tr_b16 v[106:107], v9 offset:23040
    v_mfma_f32_32x32x16_bf16 v[160:175], v[116:119], v[108:111], v[160:175]
    v_mfma_f32_32x32x16_bf16 v[176:191], v[116:119], v[120:123], v[176:191]
    ds_read_b128 v[116:119], v79 offset:0
    v_mfma_f32_32x32x16_bf16 v[192:207], v[124:127], v[108:111], v[192:207]
    v_mfma_f32_32x32x16_bf16 v[208:223], v[124:127], v[120:123], v[208:223]
    ds_read_b128 v[124:127], v79 offset:4096
    v_mfma_f32_32x32x16_bf16 v[224:239], v[112:115], v[108:111], v[224:239]
    ds_read_b64_tr_b16 v[108:109], v9 offset:30720
    ds_read_b64_tr_b16 v[110:111], v9 offset:31232
    v_mfma_f32_32x32x16_bf16 v[240:255], v[112:115], v[120:123], v[240:255]
    ds_read_b64_tr_b16 v[112:113], v9 offset:38912
    ds_read_b64_tr_b16 v[114:115], v9 offset:39424
    v_mfma_f32_32x32x16_bf16 v[128:143], v[80:83], v[92:95], v[128:143]
    ds_read_b64_tr_b16 v[120:121], v9 offset:47104
    ds_read_b64_tr_b16 v[122:123], v9 offset:47616
    s_waitcnt lgkmcnt(6)
    v_mfma_f32_32x32x16_bf16 v[144:159], v[80:83], v[100:103], v[144:159]
    v_mfma_f32_32x32x16_bf16 v[160:175], v[84:87], v[92:95], v[160:175]
    v_mfma_f32_32x32x16_bf16 v[176:191], v[84:87], v[100:103], v[176:191]
    v_mfma_f32_32x32x16_bf16 v[192:207], v[88:91], v[92:95], v[192:207]
    v_mfma_f32_32x32x16_bf16 v[208:223], v[88:91], v[100:103], v[208:223]
    v_mfma_f32_32x32x16_bf16 v[224:239], v[96:99], v[92:95], v[224:239]
    v_mfma_f32_32x32x16_bf16 v[240:255], v[96:99], v[100:103], v[240:255]
    v_mfma_f32_32x32x16_bf16 v[128:143], v[104:107], v[116:119], v[128:143]
    s_mov_b32 s59, 0
L_opnd:
    s_waitcnt vmcnt(0) lgkmcnt(0)
    v_cmp_ne_u32 vcc, s78, v42
    v_cmp_ne_u32 s[74:75], s78, v46
    s_or_b64 vcc, vcc, s[74:75]
    v_cmp_ne_u32 s[74:75], s78, v50
    s_or_b64 vcc, vcc, s[74:75]
    v_cmp_ne_u32 s[74:75], s78, v54
    s_or_b64 vcc, vcc, s[74:75]
    v_cmp_ne_u32 s[74:75], s78, v58
    s_or_b64 vcc, vcc, s[74:75]
    v_cmp_ne_u32 s[74:75], s78, v62
    s_or_b64 vcc, vcc, s[74:75]
    s_cbranch_vccz L_opnd_ok
    s_add_u32 s59, s59, 1
    s_cmp_lt_u32 s59, 0x40000
    s_cbranch_scc0 L_opnd_ok
    s_sleep 12
    buffer_load_dwordx4 v[40:43], v13, s[44:47], s62 offen offset:0 sc1
    buffer_load_dwordx4 v[44:47], v13, s[44:47], s62 offen offset:512 sc1
    buffer_load_dwordx4 v[48:51], v13, s[44:47], s63 offen offset:0 sc1
    buffer_load_dwordx4 v[52:55], v13, s[44:47], s64 offen offset:0 sc1
    buffer_load_dwordx4 v[56:59], v13, s[44:47], s63 offen offset:1024 sc1
    buffer_load_dwordx4 v[60:63], v13, s[44:47], s64 offen offset:1024 sc1
    s_branch L_opnd
L_opnd_ok:
    v_cmp_gt_u32 vcc, 32, v1
    v_xor_b32 v40, 0x80000000, v40
    s_nop 0
    v_cndmask_b32 v40, 0, v40, vcc
    v_lshrrev_b32 v65, 16, v40
    v_or_b32 v64, v65, v40
    v_mul_f32 v41, 0xbfb8aa3b, v41
    v_xor_b32 v44, 0x80000000, v44
    v_cndmask_b32 v44, 0, v44, vcc
    v_lshrrev_b32 v69, 16, v44
    v_or_b32 v68, v69, v44
    v_mul_f32 v45, 0xbfb8aa3b, v45
    v_mfma_f32_32x32x16_bf16 v[128:143], v[48:51], v[64:67], v[128:143]
    v_mfma_f32_32x32x16_bf16 v[144:159], v[48:51], v[68:71], v[144:159]
    v_mfma_f32_32x32x16_bf16 v[160:175], v[52:55], v[64:67], v[160:175]
    v_mfma_f32_32x32x16_bf16 v[176:191], v[52:55], v[68:71], v[176:191]
    v_mfma_f32_32x32x16_bf16 v[192:207], v[56:59], v[64:67], v[192:207]
    v_mfma_f32_32x32x16_bf16 v[208:223], v[56:59], v[68:71], v[208:223]
    v_mfma_f32_32x32x16_bf16 v[224:239], v[60:63], v[64:67], v[224:239]
    v_mfma_f32_32x32x16_bf16 v[240:255], v[60:63], v[68:71], v[240:255]
    s_waitcnt lgkmcnt(0)
    s_barrier
    ds_read_b64_tr_b16 v[80:81], v8 offset:32768
    ds_read_b64_tr_b16 v[82:83], v8 offset:33280
    ds_read_b128 v[84:87], v4 offset:0
    v_mfma_f32_32x32x16_bf16 v[144:159], v[104:107], v[124:127], v[144:159]
    ds_read_b128 v[88:91], v4 offset:4096
    ds_read_b64_tr_b16 v[92:93], v8 offset:40960
    ds_read_b64_tr_b16 v[94:95], v8 offset:41472
    v_mfma_f32_32x32x16_bf16 v[160:175], v[108:111], v[116:119], v[160:175]
    ds_read_b64_tr_b16 v[96:97], v8 offset:34816
    ds_read_b64_tr_b16 v[98:99], v8 offset:35328
    v_mfma_f32_32x32x16_bf16 v[176:191], v[108:111], v[124:127], v[176:191]
    ds_read_b128 v[100:103], v5 offset:0
    ds_read_b128 v[104:107], v5 offset:4096
    v_mfma_f32_32x32x16_bf16 v[192:207], v[112:115], v[116:119], v[192:207]
    ds_read_b64_tr_b16 v[108:109], v8 offset:43008
    ds_read_b64_tr_b16 v[110:111], v8 offset:43520
    v_mfma_f32_32x32x16_bf16 v[208:223], v[112:115], v[124:127], v[208:223]
    ds_read_b64_tr_b16 v[112:113], v8 offset:36864
    ds_read_b64_tr_b16 v[114:115], v8 offset:37376
    v_mfma_f32_32x32x16_bf16 v[224:239], v[120:123], v[116:119], v[224:239]
    ds_read_b128 v[116:119], v6 offset:0
    v_mfma_f32_32x32x16_bf16 v[240:255], v[120:123], v[124:127], v[240:255]
    ds_read_b128 v[120:123], v6 offset:4096
    ds_read_b64_tr_b16 v[124:125], v8 offset:45056
    ds_read_b64_tr_b16 v[126:127], v8 offset:45568
    s_waitcnt lgkmcnt(6)
    v_mfma_f32_32x32x16_bf16 v[192:207], v[80:83], v[84:87], v[192:207]
    v_mfma_f32_32x32x16_bf16 v[208:223], v[80:83], v[88:91], v[208:223]
    ds_read_b64_tr_b16 v[80:81], v8 offset:38912
    ds_read_b64_tr_b16 v[82:83], v8 offset:39424
    v_mfma_f32_32x32x16_bf16 v[224:239], v[92:95], v[84:87], v[224:239]
    ds_read_b128 v[84:87], v7 offset:0
    v_mfma_f32_32x32x16_bf16 v[240:255], v[92:95], v[88:91], v[240:255]
    ds_read_b128 v[92:95], v7 offset:4096
    ds_read_b64_tr_b16 v[88:89], v8 offset:47104
    ds_read_b64_tr_b16 v[90:91], v8 offset:47616
    v_mfma_f32_32x32x16_bf16 v[192:207], v[96:99], v[100:103], v[192:207]
    v_mfma_f32_32x32x16_bf16 v[208:223], v[96:99], v[104:107], v[208:223]
    ds_read_b64_tr_b16 v[96:97], v8 offset:16384
    ds_read_b64_tr_b16 v[98:99], v8 offset:16896
    v_mfma_f32_32x32x16_bf16 v[224:239], v[108:111], v[100:103], v[224:239]
    ds_read_b128 v[100:103], v4 offset:0
    v_mfma_f32_32x32x16_bf16 v[240:255], v[108:111], v[104:107], v[240:255]
    ds_read_b128 v[108:111], v4 offset:4096
    ds_read_b64_tr_b16 v[104:105], v8 offset:24576
    ds_read_b64_tr_b16 v[106:107], v8 offset:25088
    s_waitcnt lgkmcnt(6)
    v_mfma_f32_32x32x16_bf16 v[192:207], v[112:115], v[116:119], v[192:207]
    v_mfma_f32_32x32x16_bf16 v[208:223], v[112:115], v[120:123], v[208:223]
    ds_read_b64_tr_b16 v[112:113], v8 offset:18432
    ds_read_b64_tr_b16 v[114:115], v8 offset:18944
    v_mfma_f32_32x32x16_bf16 v[224:239], v[124:127], v[116:119], v[224:239]
    ds_read_b128 v[116:119], v5 offset:0
    v_mfma_f32_32x32x16_bf16 v[240:255], v[124:127], v[120:123], v[240:255]
    ds_read_b128 v[124:127], v5 offset:4096
    ds_read_b64_tr_b16 v[120:121], v8 offset:26624
    ds_read_b64_tr_b16 v[122:123], v8 offset:27136
    v_mfma_f32_32x32x16_bf16 v[192:207], v[80:83], v[84:87], v[192:207]
    v_mfma_f32_32x32x16_bf16 v[208:223], v[80:83], v[92:95], v[208:223]
    ds_read_b64_tr_b16 v[80:81], v8 offset:20480
    ds_read_b64_tr_b16 v[82:83], v8 offset:20992
    v_mfma_f32_32x32x16_bf16 v[224:239], v[88:91], v[84:87], v[224:239]
    ds_read_b128 v[84:87], v6 offset:0
    v_mfma_f32_32x32x16_bf16 v[240:255], v[88:91], v[92:95], v[240:255]
    ds_read_b128 v[88:91], v6 offset:4096
    ds_read_b64_tr_b16 v[92:93], v8 offset:28672
    ds_read_b64_tr_b16 v[94:95], v8 offset:29184
    s_waitcnt lgkmcnt(6)
    v_mfma_f32_32x32x16_bf16 v[128:143], v[96:99], v[100:103], v[128:143]
    v_mfma_f32_32x32x16_bf16 v[144:159], v[96:99], v[108:111], v[144:159]
    ds_read_b64_tr_b16 v[96:97], v8 offset:22528
    ds_read_b64_tr_b16 v[98:99], v8 offset:23040
    v_mul_f32 v20, v41, v192
    v_mul_f32 v21, v41, v193
    v_exp_f32 v20, v20
    v_mfma_f32_32x32x16_bf16 v[160:175], v[104:107], v[100:103], v[160:175]
    ds_read_b128 v[100:103], v7 offset:0
    v_mul_f32 v192, v192, v224
    v_mul_f32 v22, v41, v194
    v_exp_f32 v21, v21
    v_mul_f32 v193, v193, v225
    v_mfma_f32_32x32x16_bf16 v[176:191], v[104:107], v[108:111], v[176:191]
    ds_read_b128 v[104:107], v7 offset:4096
    ds_read_b64_tr_b16 v[108:109], v8 offset:30720
    ds_read_b64_tr_b16 v[110:111], v8 offset:31232
    ds_write_b32 v3, v15 offset:0
    v_add_f32 v20, 1.0, v20
    v_mul_f32 v23, v41, v195
    v_mfma_f32_32x32x16_bf16 v[128:143], v[112:115], v[116:119], v[128:143]
    v_exp_f32 v22, v22
    v_mul_f32 v194, v194, v226
    v_add_f32 v21, 1.0, v21
    v_mul_f32 v24, v41, v196
    v_mfma_f32_32x32x16_bf16 v[144:159], v[112:115], v[124:127], v[144:159]
    v_exp_f32 v23, v23
    v_mul_f32 v195, v195, v227
    v_add_f32 v22, 1.0, v22
    v_mul_f32 v25, v41, v197
    v_mfma_f32_32x32x16_bf16 v[160:175], v[120:123], v[116:119], v[160:175]
    v_exp_f32 v24, v24
    v_mul_f32 v196, v196, v228
    v_add_f32 v23, 1.0, v23
    v_mul_f32 v26, v41, v198
    v_mfma_f32_32x32x16_bf16 v[176:191], v[120:123], v[124:127], v[176:191]
    v_exp_f32 v25, v25
    v_mul_f32 v197, v197, v229
    v_add_f32 v24, 1.0, v24
    v_mul_f32 v27, v41, v199
    s_waitcnt lgkmcnt(1)
    v_mfma_f32_32x32x16_bf16 v[128:143], v[80:83], v[84:87], v[128:143]
    v_exp_f32 v26, v26
    v_mul_f32 v198, v198, v230
    v_add_f32 v25, 1.0, v25
    v_exp_f32 v27, v27
    v_mfma_f32_32x32x16_bf16 v[144:159], v[80:83], v[88:91], v[144:159]
    v_mul_f32 v199, v199, v231
    v_add_f32 v26, 1.0, v26
    v_add_f32 v27, 1.0, v27
    v_rcp_f32 v20, v20
    v_mfma_f32_32x32x16_bf16 v[160:175], v[92:95], v[84:87], v[160:175]
    v_rcp_f32 v21, v21
    v_mul_f32 v192, v192, v20
    v_rcp_f32 v22, v22
    v_mul_f32 v193, v193, v21
    v_mfma_f32_32x32x16_bf16 v[176:191], v[92:95], v[88:91], v[176:191]
    v_cvt_pk_bf16_f32 v224, v192, v193
    v_rcp_f32 v23, v23
    v_mul_f32 v194, v194, v22
    v_rcp_f32 v24, v24
    v_mfma_f32_32x32x16_bf16 v[128:143], v[96:99], v[100:103], v[128:143]
    v_mul_f32 v195, v195, v23
    v_cvt_pk_bf16_f32 v225, v194, v195
    v_rcp_f32 v25, v25
    v_mul_f32 v196, v196, v24
    v_mfma_f32_32x32x16_bf16 v[144:159], v[96:99], v[104:107], v[144:159]
    v_rcp_f32 v26, v26
    v_mul_f32 v197, v197, v25
    v_cvt_pk_bf16_f32 v226, v196, v197
    v_rcp_f32 v27, v27
    v_mfma_f32_32x32x16_bf16 v[160:175], v[108:111], v[100:103], v[160:175]
    v_mul_f32 v198, v198, v26
    v_mul_f32 v199, v199, v27
    v_cvt_pk_bf16_f32 v227, v198, v199
    v_mul_f32 v28, v41, v200
    v_mul_f32 v29, v41, v201
    v_mfma_f32_32x32x16_bf16 v[176:191], v[108:111], v[104:107], v[176:191]
    v_exp_f32 v28, v28
    v_mul_f32 v200, v200, v232
    v_mul_f32 v30, v41, v202
    v_exp_f32 v29, v29
    v_mul_f32 v201, v201, v233
    v_add_f32 v28, 1.0, v28
    v_mul_f32 v31, v41, v203
    v_exp_f32 v30, v30
    v_mul_f32 v202, v202, v234
    v_add_f32 v29, 1.0, v29
    v_mul_f32 v32, v41, v204
    v_exp_f32 v31, v31
    v_mul_f32 v203, v203, v235
    v_add_f32 v30, 1.0, v30
    v_mul_f32 v33, v41, v205
    v_exp_f32 v32, v32
    v_mul_f32 v204, v204, v236
    v_add_f32 v31, 1.0, v31
    v_mul_f32 v34, v41, v206
    v_exp_f32 v33, v33
    v_mul_f32 v205, v205, v237
    v_add_f32 v32, 1.0, v32
    v_mul_f32 v35, v41, v207
    v_exp_f32 v34, v34
    v_mul_f32 v206, v206, v238
    v_add_f32 v33, 1.0, v33
    v_exp_f32 v35, v35
    v_mul_f32 v207, v207, v239
    v_add_f32 v34, 1.0, v34
    v_add_f32 v35, 1.0, v35
    v_rcp_f32 v28, v28
    v_rcp_f32 v29, v29
    v_mul_f32 v200, v200, v28
    v_rcp_f32 v30, v30
    v_mul_f32 v201, v201, v29
    v_cvt_pk_bf16_f32 v232, v200, v201
    v_rcp_f32 v31, v31
    v_mul_f32 v202, v202, v30
    v_rcp_f32 v32, v32
    v_mul_f32 v203, v203, v31
    v_cvt_pk_bf16_f32 v233, v202, v203
    v_rcp_f32 v33, v33
    v_mul_f32 v204, v204, v32
    v_rcp_f32 v34, v34
    v_mul_f32 v205, v205, v33
    v_cvt_pk_bf16_f32 v234, v204, v205
    v_rcp_f32 v35, v35
    v_mul_f32 v206, v206, v34
    v_mul_f32 v207, v207, v35
    v_cvt_pk_bf16_f32 v235, v206, v207
    v_mul_f32 v20, v45, v208
    v_mul_f32 v21, v45, v209
    v_exp_f32 v20, v20
    v_mul_f32 v208, v208, v240
    v_mul_f32 v22, v45, v210
    v_exp_f32 v21, v21
    v_mul_f32 v209, v209, v241
    v_add_f32 v20, 1.0, v20
    v_mul_f32 v23, v45, v211
    v_exp_f32 v22, v22
    v_mul_f32 v210, v210, v242
    v_add_f32 v21, 1.0, v21
    v_mul_f32 v24, v45, v212
    v_exp_f32 v23, v23
    v_mul_f32 v211, v211, v243
    v_add_f32 v22, 1.0, v22
    v_mul_f32 v25, v45, v213
    v_exp_f32 v24, v24
    v_mul_f32 v212, v212, v244
    v_add_f32 v23, 1.0, v23
    v_mul_f32 v26, v45, v214
    v_exp_f32 v25, v25
    v_mul_f32 v213, v213, v245
    v_add_f32 v24, 1.0, v24
    v_mul_f32 v27, v45, v215
    v_exp_f32 v26, v26
    v_mul_f32 v214, v214, v246
    v_add_f32 v25, 1.0, v25
    v_exp_f32 v27, v27
    v_mul_f32 v215, v215, v247
    v_add_f32 v26, 1.0, v26
    v_add_f32 v27, 1.0, v27
    v_rcp_f32 v20, v20
    v_rcp_f32 v21, v21
    v_mul_f32 v208, v208, v20
    v_rcp_f32 v22, v22
    v_mul_f32 v209, v209, v21
    v_cvt_pk_bf16_f32 v240, v208, v209
    v_rcp_f32 v23, v23
    v_mul_f32 v210, v210, v22
    v_rcp_f32 v24, v24
    v_mul_f32 v211, v211, v23
    v_cvt_pk_bf16_f32 v241, v210, v211
    v_rcp_f32 v25, v25
    v_mul_f32 v212, v212, v24
    v_rcp_f32 v26, v26
    v_mul_f32 v213, v213, v25
    v_cvt_pk_bf16_f32 v242, v212, v213
    v_rcp_f32 v27, v27
    v_mul_f32 v214, v214, v26
    v_mul_f32 v215, v215, v27
    v_cvt_pk_bf16_f32 v243, v214, v215
    v_mul_f32 v28, v45, v216
    v_mul_f32 v29, v45, v217
    v_exp_f32 v28, v28
    v_mul_f32 v216, v216, v248
    v_mul_f32 v30, v45, v218
    v_exp_f32 v29, v29
    v_mul_f32 v217, v217, v249
    v_add_f32 v28, 1.0, v28
    v_mul_f32 v31, v45, v219
    v_exp_f32 v30, v30
    v_mul_f32 v218, v218, v250
    v_add_f32 v29, 1.0, v29
    v_mul_f32 v32, v45, v220
    v_exp_f32 v31, v31
    v_mul_f32 v219, v219, v251
    v_add_f32 v30, 1.0, v30
    v_mul_f32 v33, v45, v221
    v_exp_f32 v32, v32
    v_mul_f32 v220, v220, v252
    v_add_f32 v31, 1.0, v31
    v_mul_f32 v34, v45, v222
    v_exp_f32 v33, v33
    v_mul_f32 v221, v221, v253
    v_add_f32 v32, 1.0, v32
    v_mul_f32 v35, v45, v223
    v_exp_f32 v34, v34
    v_mul_f32 v222, v222, v254
    v_add_f32 v33, 1.0, v33
    v_exp_f32 v35, v35
    v_mul_f32 v223, v223, v255
    v_add_f32 v34, 1.0, v34
    v_add_f32 v35, 1.0, v35
    v_rcp_f32 v28, v28
    v_rcp_f32 v29, v29
    v_mul_f32 v216, v216, v28
    v_rcp_f32 v30, v30
    v_mul_f32 v217, v217, v29
    v_cvt_pk_bf16_f32 v248, v216, v217
    v_rcp_f32 v31, v31
    v_mul_f32 v218, v218, v30
    v_rcp_f32 v32, v32
    v_mul_f32 v219, v219, v31
    v_cvt_pk_bf16_f32 v249, v218, v219
    v_rcp_f32 v33, v33
    v_mul_f32 v220, v220, v32
    v_rcp_f32 v34, v34
    v_mul_f32 v221, v221, v33
    v_cvt_pk_bf16_f32 v250, v220, v221
    v_rcp_f32 v35, v35
    v_mul_f32 v222, v222, v34
    v_mul_f32 v223, v223, v35
    v_cvt_pk_bf16_f32 v251, v222, v223
    buffer_store_dwordx4 v[224:227], v2, s[44:47], s70 offen offset:0 sc1
    buffer_store_dwordx4 v[232:235], v2, s[44:47], s70 offen offset:1024 sc1
    buffer_store_dwordx4 v[240:243], v2, s[44:47], s71 offen offset:0 sc1
    buffer_store_dwordx4 v[248:251], v2, s[44:47], s71 offen offset:1024 sc1
    v_mul_f32 v20, v41, v128
    v_mul_f32 v21, v41, v129
    v_exp_f32 v20, v20
    v_mul_f32 v128, v128, v160
    v_mul_f32 v22, v41, v130
    v_exp_f32 v21, v21
    v_mul_f32 v129, v129, v161
    v_add_f32 v20, 1.0, v20
    v_mul_f32 v23, v41, v131
    v_exp_f32 v22, v22
    v_mul_f32 v130, v130, v162
    v_add_f32 v21, 1.0, v21
    v_mul_f32 v24, v41, v132
    v_exp_f32 v23, v23
    v_mul_f32 v131, v131, v163
    v_add_f32 v22, 1.0, v22
    v_mul_f32 v25, v41, v133
    v_exp_f32 v24, v24
    v_mul_f32 v132, v132, v164
    v_add_f32 v23, 1.0, v23
    v_mul_f32 v26, v41, v134
    v_exp_f32 v25, v25
    v_mul_f32 v133, v133, v165
    v_add_f32 v24, 1.0, v24
    v_mul_f32 v27, v41, v135
    v_exp_f32 v26, v26
    v_mul_f32 v134, v134, v166
    v_add_f32 v25, 1.0, v25
    v_exp_f32 v27, v27
    v_mul_f32 v135, v135, v167
    v_add_f32 v26, 1.0, v26
    v_add_f32 v27, 1.0, v27
    v_rcp_f32 v20, v20
    v_rcp_f32 v21, v21
    v_mul_f32 v128, v128, v20
    v_rcp_f32 v22, v22
    v_mul_f32 v129, v129, v21
    v_cvt_pk_bf16_f32 v160, v128, v129
    v_rcp_f32 v23, v23
    v_mul_f32 v130, v130, v22
    v_rcp_f32 v24, v24
    v_mul_f32 v131, v131, v23
    v_cvt_pk_bf16_f32 v161, v130, v131
    v_rcp_f32 v25, v25
    v_mul_f32 v132, v132, v24
    v_rcp_f32 v26, v26
    v_mul_f32 v133, v133, v25
    v_cvt_pk_bf16_f32 v162, v132, v133
    v_rcp_f32 v27, v27
    v_mul_f32 v134, v134, v26
    v_mul_f32 v135, v135, v27
    v_cvt_pk_bf16_f32 v163, v134, v135
    v_mul_f32 v28, v41, v136
    v_mul_f32 v29, v41, v137
    v_exp_f32 v28, v28
    v_mul_f32 v136, v136, v168
    v_mul_f32 v30, v41, v138
    v_exp_f32 v29, v29
    v_mul_f32 v137, v137, v169
    v_add_f32 v28, 1.0, v28
    v_mul_f32 v31, v41, v139
    v_exp_f32 v30, v30
    v_mul_f32 v138, v138, v170
    v_add_f32 v29, 1.0, v29
    v_mul_f32 v32, v41, v140
    v_exp_f32 v31, v31
    v_mul_f32 v139, v139, v171
    v_add_f32 v30, 1.0, v30
    v_mul_f32 v33, v41, v141
    v_exp_f32 v32, v32
    v_mul_f32 v140, v140, v172
    v_add_f32 v31, 1.0, v31
    v_mul_f32 v34, v41, v142
    v_exp_f32 v33, v33
    v_mul_f32 v141, v141, v173
    v_add_f32 v32, 1.0, v32
    v_mul_f32 v35, v41, v143
    v_exp_f32 v34, v34
    v_mul_f32 v142, v142, v174
    v_add_f32 v33, 1.0, v33
    v_exp_f32 v35, v35
    v_mul_f32 v143, v143, v175
    v_add_f32 v34, 1.0, v34
    v_add_f32 v35, 1.0, v35
    v_rcp_f32 v28, v28
    v_rcp_f32 v29, v29
    v_mul_f32 v136, v136, v28
    v_rcp_f32 v30, v30
    v_mul_f32 v137, v137, v29
    v_cvt_pk_bf16_f32 v168, v136, v137
    v_rcp_f32 v31, v31
    v_mul_f32 v138, v138, v30
    v_rcp_f32 v32, v32
    v_mul_f32 v139, v139, v31
    v_cvt_pk_bf16_f32 v169, v138, v139
    v_rcp_f32 v33, v33
    v_mul_f32 v140, v140, v32
    v_rcp_f32 v34, v34
    v_mul_f32 v141, v141, v33
    v_cvt_pk_bf16_f32 v170, v140, v141
    v_rcp_f32 v35, v35
    v_mul_f32 v142, v142, v34
    v_mul_f32 v143, v143, v35
    v_cvt_pk_bf16_f32 v171, v142, v143
    v_mul_f32 v20, v45, v144
    v_mul_f32 v21, v45, v145
    v_exp_f32 v20, v20
    v_mul_f32 v144, v144, v176
    v_mul_f32 v22, v45, v146
    v_exp_f32 v21, v21
    v_mul_f32 v145, v145, v177
    v_add_f32 v20, 1.0, v20
    v_mul_f32 v23, v45, v147
    v_exp_f32 v22, v22
    v_mul_f32 v146, v146, v178
    v_add_f32 v21, 1.0, v21
    v_mul_f32 v24, v45, v148
    v_exp_f32 v23, v23
    v_mul_f32 v147, v147, v179
    v_add_f32 v22, 1.0, v22
    v_mul_f32 v25, v45, v149
    v_exp_f32 v24, v24
    v_mul_f32 v148, v148, v180
    v_add_f32 v23, 1.0, v23
    v_mul_f32 v26, v45, v150
    v_exp_f32 v25, v25
    v_mul_f32 v149, v149, v181
    v_add_f32 v24, 1.0, v24
    v_mul_f32 v27, v45, v151
    v_exp_f32 v26, v26
    v_mul_f32 v150, v150, v182
    v_add_f32 v25, 1.0, v25
    v_exp_f32 v27, v27
    v_mul_f32 v151, v151, v183
    v_add_f32 v26, 1.0, v26
    v_add_f32 v27, 1.0, v27
    v_rcp_f32 v20, v20
    v_rcp_f32 v21, v21
    v_mul_f32 v144, v144, v20
    v_rcp_f32 v22, v22
    v_mul_f32 v145, v145, v21
    v_cvt_pk_bf16_f32 v176, v144, v145
    v_rcp_f32 v23, v23
    v_mul_f32 v146, v146, v22
    v_rcp_f32 v24, v24
    v_mul_f32 v147, v147, v23
    v_cvt_pk_bf16_f32 v177, v146, v147
    v_rcp_f32 v25, v25
    v_mul_f32 v148, v148, v24
    v_rcp_f32 v26, v26
    v_mul_f32 v149, v149, v25
    v_cvt_pk_bf16_f32 v178, v148, v149
    v_rcp_f32 v27, v27
    v_mul_f32 v150, v150, v26
    v_mul_f32 v151, v151, v27
    v_cvt_pk_bf16_f32 v179, v150, v151
    v_mul_f32 v28, v45, v152
    v_mul_f32 v29, v45, v153
    v_exp_f32 v28, v28
    v_mul_f32 v152, v152, v184
    v_mul_f32 v30, v45, v154
    v_exp_f32 v29, v29
    v_mul_f32 v153, v153, v185
    v_add_f32 v28, 1.0, v28
    v_mul_f32 v31, v45, v155
    v_exp_f32 v30, v30
    v_mul_f32 v154, v154, v186
    v_add_f32 v29, 1.0, v29
    v_mul_f32 v32, v45, v156
    v_exp_f32 v31, v31
    v_mul_f32 v155, v155, v187
    v_add_f32 v30, 1.0, v30
    v_mul_f32 v33, v45, v157
    v_exp_f32 v32, v32
    v_mul_f32 v156, v156, v188
    v_add_f32 v31, 1.0, v31
    v_mul_f32 v34, v45, v158
    v_exp_f32 v33, v33
    v_mul_f32 v157, v157, v189
    v_add_f32 v32, 1.0, v32
    v_mul_f32 v35, v45, v159
    v_exp_f32 v34, v34
    v_mul_f32 v158, v158, v190
    v_add_f32 v33, 1.0, v33
    v_exp_f32 v35, v35
    v_mul_f32 v159, v159, v191
    v_add_f32 v34, 1.0, v34
    v_add_f32 v35, 1.0, v35
    v_rcp_f32 v28, v28
    v_rcp_f32 v29, v29
    v_mul_f32 v152, v152, v28
    v_rcp_f32 v30, v30
    v_mul_f32 v153, v153, v29
    v_cvt_pk_bf16_f32 v184, v152, v153
    v_rcp_f32 v31, v31
    v_mul_f32 v154, v154, v30
    v_rcp_f32 v32, v32
    v_mul_f32 v155, v155, v31
    v_cvt_pk_bf16_f32 v185, v154, v155
    v_rcp_f32 v33, v33
    v_mul_f32 v156, v156, v32
    v_rcp_f32 v34, v34
    v_mul_f32 v157, v157, v33
    v_cvt_pk_bf16_f32 v186, v156, v157
    v_rcp_f32 v35, v35
    v_mul_f32 v158, v158, v34
    v_mul_f32 v159, v159, v35
    v_cvt_pk_bf16_f32 v187, v158, v159
    s_waitcnt vmcnt(0)
    v_mov_b32 v36, 0
    v_mov_b32 v37, s78
    s_mov_b64 exec, 1
    buffer_store_dword v37, v36, s[44:47], s73 offen sc1
    s_mov_b64 exec, -1
    buffer_store_dwordx4 v[160:163], v2, s[44:47], s68 offen offset:0 sc1
    buffer_store_dwordx4 v[168:171], v2, s[44:47], s68 offen offset:1024 sc1
    buffer_store_dwordx4 v[176:179], v2, s[44:47], s69 offen offset:0 sc1
    buffer_store_dwordx4 v[184:187], v2, s[44:47], s69 offen offset:1024 sc1
    s_mov_b32 s76, s72
    s_mul_i32 s74, s52, 28
    s_add_u32 s74, s74, s56
    s_sub_u32 s74, s74, 4
    s_and_b32 s65, s48, 1
    s_lshr_b32 s66, s48, 1
    s_lshl_b32 s67, s74, 1
    s_add_u32 s67, s67, s65
    s_mul_i32 s71, s65, 18176
    s_add_u32 s71, s71, 114688
    v_and_b32 v12, 15, v1
    v_lshrrev_b32 v13, 4, v1
    v_and_b32 v14, 1, v12
    v_mov_b32 v17, 4480
    v_mov_b32 v16, 4
    v_cmp_eq_u32 vcc, 1, v14
    s_nop 1
    v_cndmask_b32 v17, v17, v16, vcc
    v_lshl_add_u32 v17, v12, 2, v17
    v_lshl_add_u32 v17, v13, 4, v17
    v_add_u32 v17, s71, v17
    s_lshl_b32 s72, s66, 8
    v_add_u32 v8, s72, v17
    s_add_u32 s58, s71, 13056
    v_mov_b32 v16, s58
    s_cmp_eq_u32 s66, 0
    s_cselect_b64 vcc, -1, 0
    v_cndmask_b32 v11, v16, v17, vcc
    v_mov_b32 v17, 9408
    v_mov_b32 v16, 13984
    v_cmp_eq_u32 vcc, 1, v14
    s_nop 1
    v_cndmask_b32 v17, v17, v16, vcc
    v_lshrrev_b32 v16, 1, v12
    v_lshlrev_b32 v16, 6, v16
    v_sub_u32 v17, v17, v16
    v_lshl_add_u32 v17, v13, 4, v17
    s_add_u32 s72, s72, s71
    v_add_u32 v9, s72, v17
    s_mov_b32 s58, 0
L_lw10:
    ds_read_b32 v10, v0 offset:48
    s_waitcnt lgkmcnt(0)
    v_cmp_ne_u32 vcc, s78, v10
    s_cbranch_vccz L_lwd10
    s_add_u32 s58, s58, 1
    s_cmp_lt_u32 s58, 0x400000
    s_cbranch_scc0 L_lwd10
    s_sleep 1
    s_branch L_lw10
L_lwd10:
    s_setprio 0
    ds_read_b64 v[4:5], v11
    ds_read_b64 v[6:7], v11 offset:8
    ds_read_b64 v[80:81], v8 offset:192
    ds_read_b64 v[82:83], v8 offset:200
    ds_read_b128 v[96:99], v9 offset:3584
    ds_read_b64 v[84:85], v8 offset:704
    ds_read_b64 v[86:87], v8 offset:712
    ds_read_b128 v[100:103], v9 offset:3072
    ds_read_b64 v[88:89], v8 offset:1216
    ds_read_b64 v[90:91], v8 offset:1224
    ds_read_b128 v[104:107], v9 offset:2560
    ds_read_b64 v[92:93], v8 offset:1728
    ds_read_b64 v[94:95], v8 offset:1736
    ds_read_b128 v[108:111], v9 offset:2048
    s_waitcnt lgkmcnt(0)
    v_mfma_f32_16x16x32_bf16 v[16:19], v[4:7], v[96:99], 0
    ds_read_b64 v[48:49], v8 offset:2240
    v_mfma_f32_16x16x32_bf16 v[20:23], v[4:7], v[100:103], 0
    ds_read_b64 v[50:51], v8 offset:2248
    v_mfma_f32_16x16x32_bf16 v[24:27], v[4:7], v[104:107], 0
    ds_read_b128 v[64:67], v9 offset:1536
    v_mfma_f32_16x16x32_bf16 v[28:31], v[4:7], v[108:111], 0
    ds_read_b64 v[52:53], v8 offset:2752
    v_mfma_f32_16x16x32_bf16 v[16:19], v[80:83], v[96:99], v[16:19]
    ds_read_b64 v[54:55], v8 offset:2760
    v_mfma_f32_16x16x32_bf16 v[20:23], v[80:83], v[100:103], v[20:23]
    ds_read_b128 v[68:71], v9 offset:1024
    v_mfma_f32_16x16x32_bf16 v[24:27], v[80:83], v[104:107], v[24:27]
    ds_read_b64 v[56:57], v8 offset:3264
    v_mfma_f32_16x16x32_bf16 v[28:31], v[80:83], v[108:111], v[28:31]
    ds_read_b64 v[58:59], v8 offset:3272
    v_mfma_f32_16x16x32_bf16 v[20:23], v[84:87], v[96:99], v[20:23]
    ds_read_b128 v[72:75], v9 offset:512
    v_mfma_f32_16x16x32_bf16 v[24:27], v[84:87], v[100:103], v[24:27]
    ds_read_b64 v[60:61], v8 offset:3776
    v_mfma_f32_16x16x32_bf16 v[28:31], v[84:87], v[104:107], v[28:31]
    ds_read_b64 v[62:63], v8 offset:3784
    v_mfma_f32_16x16x32_bf16 v[32:35], v[84:87], v[108:111], 0
    ds_read_b128 v[76:79], v9 offset:0
    v_mfma_f32_16x16x32_bf16 v[24:27], v[88:91], v[96:99], v[24:27]
    v_mfma_f32_16x16x32_bf16 v[28:31], v[88:91], v[100:103], v[28:31]
    v_mfma_f32_16x16x32_bf16 v[32:35], v[88:91], v[104:107], v[32:35]
    v_mfma_f32_16x16x32_bf16 v[36:39], v[88:91], v[108:111], 0
    v_mfma_f32_16x16x32_bf16 v[28:31], v[92:95], v[96:99], v[28:31]
    v_mfma_f32_16x16x32_bf16 v[32:35], v[92:95], v[100:103], v[32:35]
    v_mfma_f32_16x16x32_bf16 v[36:39], v[92:95], v[104:107], v[36:39]
    v_mfma_f32_16x16x32_bf16 v[40:43], v[92:95], v[108:111], 0
    s_waitcnt lgkmcnt(0)
    v_mfma_f32_16x16x32_bf16 v[32:35], v[48:51], v[96:99], v[32:35]
    ds_read_b64 v[112:113], v8 offset:256
    v_mfma_f32_16x16x32_bf16 v[32:35], v[80:83], v[64:67], v[32:35]
    ds_read_b64 v[114:115], v8 offset:264
    v_mfma_f32_16x16x32_bf16 v[36:39], v[48:51], v[100:103], v[36:39]
    ds_read_b128 v[128:131], v9 offset:3648
    v_mfma_f32_16x16x32_bf16 v[36:39], v[84:87], v[64:67], v[36:39]
    ds_read_b64 v[116:117], v8 offset:768
    v_mfma_f32_16x16x32_bf16 v[40:43], v[48:51], v[104:107], v[40:43]
    ds_read_b64 v[118:119], v8 offset:776
    v_mfma_f32_16x16x32_bf16 v[40:43], v[88:91], v[64:67], v[40:43]
    ds_read_b128 v[132:135], v9 offset:3136
    v_mfma_f32_16x16x32_bf16 v[44:47], v[48:51], v[108:111], 0
    ds_read_b64 v[120:121], v8 offset:1280
    v_mfma_f32_16x16x32_bf16 v[44:47], v[92:95], v[64:67], v[44:47]
    ds_read_b64 v[122:123], v8 offset:1288
    v_mfma_f32_16x16x32_bf16 v[36:39], v[52:55], v[96:99], v[36:39]
    ds_read_b128 v[136:139], v9 offset:2624
    v_mfma_f32_16x16x32_bf16 v[36:39], v[80:83], v[68:71], v[36:39]
    ds_read_b64 v[124:125], v8 offset:1792
    v_mfma_f32_16x16x32_bf16 v[40:43], v[52:55], v[100:103], v[40:43]
    ds_read_b64 v[126:127], v8 offset:1800
    v_mfma_f32_16x16x32_bf16 v[40:43], v[84:87], v[68:71], v[40:43]
    ds_read_b128 v[140:143], v9 offset:2112
    v_mfma_f32_16x16x32_bf16 v[44:47], v[52:55], v[104:107], v[44:47]
    v_mfma_f32_16x16x32_bf16 v[44:47], v[88:91], v[68:71], v[44:47]
    v_mfma_f32_16x16x32_bf16 v[40:43], v[56:59], v[96:99], v[40:43]
    v_mfma_f32_16x16x32_bf16 v[40:43], v[80:83], v[72:75], v[40:43]
    v_mfma_f32_16x16x32_bf16 v[44:47], v[56:59], v[100:103], v[44:47]
    v_mfma_f32_16x16x32_bf16 v[44:47], v[84:87], v[72:75], v[44:47]
    v_mfma_f32_16x16x32_bf16 v[44:47], v[60:63], v[96:99], v[44:47]
    v_mfma_f32_16x16x32_bf16 v[44:47], v[80:83], v[76:79], v[44:47]
    v_mfma_f32_16x16x32_bf16 v[32:35], v[4:7], v[64:67], v[32:35]
    v_mfma_f32_16x16x32_bf16 v[36:39], v[4:7], v[68:71], v[36:39]
    v_mfma_f32_16x16x32_bf16 v[40:43], v[4:7], v[72:75], v[40:43]
    v_mfma_f32_16x16x32_bf16 v[44:47], v[4:7], v[76:79], v[44:47]
    s_waitcnt lgkmcnt(0)
    v_mfma_f32_16x16x32_bf16 v[16:19], v[112:115], v[128:131], v[16:19]
    ds_read_b64 v[48:49], v8 offset:2304
    v_mfma_f32_16x16x32_bf16 v[20:23], v[112:115], v[132:135], v[20:23]
    ds_read_b64 v[50:51], v8 offset:2312
    v_mfma_f32_16x16x32_bf16 v[24:27], v[112:115], v[136:139], v[24:27]
    ds_read_b128 v[64:67], v9 offset:1600
    v_mfma_f32_16x16x32_bf16 v[28:31], v[112:115], v[140:143], v[28:31]
    ds_read_b64 v[52:53], v8 offset:2816
    v_mfma_f32_16x16x32_bf16 v[20:23], v[116:119], v[128:131], v[20:23]
    ds_read_b64 v[54:55], v8 offset:2824
    v_mfma_f32_16x16x32_bf16 v[24:27], v[116:119], v[132:135], v[24:27]
    ds_read_b128 v[68:71], v9 offset:1088
    v_mfma_f32_16x16x32_bf16 v[28:31], v[116:119], v[136:139], v[28:31]
    ds_read_b64 v[56:57], v8 offset:3328
    v_mfma_f32_16x16x32_bf16 v[32:35], v[116:119], v[140:143], v[32:35]
    ds_read_b64 v[58:59], v8 offset:3336
    v_mfma_f32_16x16x32_bf16 v[24:27], v[120:123], v[128:131], v[24:27]
    ds_read_b128 v[72:75], v9 offset:576
    v_mfma_f32_16x16x32_bf16 v[28:31], v[120:123], v[132:135], v[28:31]
    ds_read_b64 v[60:61], v8 offset:3840
    v_mfma_f32_16x16x32_bf16 v[32:35], v[120:123], v[136:139], v[32:35]
    ds_read_b64 v[62:63], v8 offset:3848
    v_mfma_f32_16x16x32_bf16 v[36:39], v[120:123], v[140:143], v[36:39]
    ds_read_b128 v[76:79], v9 offset:64
    v_mfma_f32_16x16x32_bf16 v[28:31], v[124:127], v[128:131], v[28:31]
    v_mfma_f32_16x16x32_bf16 v[32:35], v[124:127], v[132:135], v[32:35]
    v_mfma_f32_16x16x32_bf16 v[36:39], v[124:127], v[136:139], v[36:39]
    v_mfma_f32_16x16x32_bf16 v[40:43], v[124:127], v[140:143], v[40:43]
    s_waitcnt lgkmcnt(0)
    v_mfma_f32_16x16x32_bf16 v[32:35], v[48:51], v[128:131], v[32:35]
    ds_read_b64 v[80:81], v8 offset:320
    v_mfma_f32_16x16x32_bf16 v[32:35], v[112:115], v[64:67], v[32:35]
    ds_read_b64 v[82:83], v8 offset:328
    v_mfma_f32_16x16x32_bf16 v[36:39], v[48:51], v[132:135], v[36:39]
    ds_read_b128 v[96:99], v9 offset:3712
    v_mfma_f32_16x16x32_bf16 v[36:39], v[116:119], v[64:67], v[36:39]
    ds_read_b64 v[84:85], v8 offset:832
    v_mfma_f32_16x16x32_bf16 v[40:43], v[48:51], v[136:139], v[40:43]
    ds_read_b64 v[86:87], v8 offset:840
    v_mfma_f32_16x16x32_bf16 v[40:43], v[120:123], v[64:67], v[40:43]
    ds_read_b128 v[100:103], v9 offset:3200
    v_mfma_f32_16x16x32_bf16 v[44:47], v[48:51], v[140:143], v[44:47]
    ds_read_b64 v[88:89], v8 offset:1344
    v_mfma_f32_16x16x32_bf16 v[44:47], v[124:127], v[64:67], v[44:47]
    ds_read_b64 v[90:91], v8 offset:1352
    v_mfma_f32_16x16x32_bf16 v[36:39], v[52:55], v[128:131], v[36:39]
    ds_read_b128 v[104:107], v9 offset:2688
    v_mfma_f32_16x16x32_bf16 v[36:39], v[112:115], v[68:71], v[36:39]
    ds_read_b64 v[92:93], v8 offset:1856
    v_mfma_f32_16x16x32_bf16 v[40:43], v[52:55], v[132:135], v[40:43]
    ds_read_b64 v[94:95], v8 offset:1864
    v_mfma_f32_16x16x32_bf16 v[40:43], v[116:119], v[68:71], v[40:43]
    ds_read_b128 v[108:111], v9 offset:2176
    v_mfma_f32_16x16x32_bf16 v[44:47], v[52:55], v[136:139], v[44:47]
    v_mfma_f32_16x16x32_bf16 v[44:47], v[120:123], v[68:71], v[44:47]
    v_mfma_f32_16x16x32_bf16 v[40:43], v[56:59], v[128:131], v[40:43]
    v_mfma_f32_16x16x32_bf16 v[40:43], v[112:115], v[72:75], v[40:43]
    v_mfma_f32_16x16x32_bf16 v[44:47], v[56:59], v[132:135], v[44:47]
    v_mfma_f32_16x16x32_bf16 v[44:47], v[116:119], v[72:75], v[44:47]
    v_mfma_f32_16x16x32_bf16 v[44:47], v[60:63], v[128:131], v[44:47]
    v_mfma_f32_16x16x32_bf16 v[44:47], v[112:115], v[76:79], v[44:47]
    s_waitcnt lgkmcnt(0)
    s_waitcnt vmcnt(0)
    v_mov_b32 v10, 0
    v_mov_b32 v11, s78
    s_mov_b64 exec, 1
    buffer_store_dword v11, v10, s[44:47], s76 offen sc1
    s_mov_b64 exec, -1
    v_mfma_f32_16x16x32_bf16 v[16:19], v[80:83], v[96:99], v[16:19]
    ds_read_b64 v[48:49], v8 offset:2368
    v_mfma_f32_16x16x32_bf16 v[20:23], v[80:83], v[100:103], v[20:23]
    ds_read_b64 v[50:51], v8 offset:2376
    v_mfma_f32_16x16x32_bf16 v[24:27], v[80:83], v[104:107], v[24:27]
    ds_read_b128 v[64:67], v9 offset:1664
    v_mfma_f32_16x16x32_bf16 v[28:31], v[80:83], v[108:111], v[28:31]
    ds_read_b64 v[52:53], v8 offset:2880
    v_mfma_f32_16x16x32_bf16 v[20:23], v[84:87], v[96:99], v[20:23]
    ds_read_b64 v[54:55], v8 offset:2888
    v_mfma_f32_16x16x32_bf16 v[24:27], v[84:87], v[100:103], v[24:27]
    ds_read_b128 v[68:71], v9 offset:1152
    v_mfma_f32_16x16x32_bf16 v[28:31], v[84:87], v[104:107], v[28:31]
    ds_read_b64 v[56:57], v8 offset:3392
    v_mfma_f32_16x16x32_bf16 v[32:35], v[84:87], v[108:111], v[32:35]
    ds_read_b64 v[58:59], v8 offset:3400
    v_mfma_f32_16x16x32_bf16 v[24:27], v[88:91], v[96:99], v[24:27]
    ds_read_b128 v[72:75], v9 offset:640
    v_mfma_f32_16x16x32_bf16 v[28:31], v[88:91], v[100:103], v[28:31]
    ds_read_b64 v[60:61], v8 offset:3904
    v_mfma_f32_16x16x32_bf16 v[32:35], v[88:91], v[104:107], v[32:35]
    ds_read_b64 v[62:63], v8 offset:3912
    v_mfma_f32_16x16x32_bf16 v[36:39], v[88:91], v[108:111], v[36:39]
    ds_read_b128 v[76:79], v9 offset:128
    v_mfma_f32_16x16x32_bf16 v[28:31], v[92:95], v[96:99], v[28:31]
    v_mfma_f32_16x16x32_bf16 v[32:35], v[92:95], v[100:103], v[32:35]
    v_mfma_f32_16x16x32_bf16 v[36:39], v[92:95], v[104:107], v[36:39]
    v_mfma_f32_16x16x32_bf16 v[40:43], v[92:95], v[108:111], v[40:43]
    s_waitcnt lgkmcnt(0)
    v_mfma_f32_16x16x32_bf16 v[32:35], v[48:51], v[96:99], v[32:35]
    ds_read_b64 v[112:113], v8 offset:384
    v_mfma_f32_16x16x32_bf16 v[32:35], v[80:83], v[64:67], v[32:35]
    ds_read_b64 v[114:115], v8 offset:392
    v_mfma_f32_16x16x32_bf16 v[36:39], v[48:51], v[100:103], v[36:39]
    ds_read_b128 v[128:131], v9 offset:3776
    v_mfma_f32_16x16x32_bf16 v[36:39], v[84:87], v[64:67], v[36:39]
    ds_read_b64 v[116:117], v8 offset:896
    v_mfma_f32_16x16x32_bf16 v[40:43], v[48:51], v[104:107], v[40:43]
    ds_read_b64 v[118:119], v8 offset:904
    v_mfma_f32_16x16x32_bf16 v[40:43], v[88:91], v[64:67], v[40:43]
    ds_read_b128 v[132:135], v9 offset:3264
    v_mfma_f32_16x16x32_bf16 v[44:47], v[48:51], v[108:111], v[44:47]
    ds_read_b64 v[120:121], v8 offset:1408
    v_mfma_f32_16x16x32_bf16 v[44:47], v[92:95], v[64:67], v[44:47]
    ds_read_b64 v[122:123], v8 offset:1416
    v_mfma_f32_16x16x32_bf16 v[36:39], v[52:55], v[96:99], v[36:39]
    ds_read_b128 v[136:139], v9 offset:2752
    v_mfma_f32_16x16x32_bf16 v[36:39], v[80:83], v[68:71], v[36:39]
    ds_read_b64 v[124:125], v8 offset:1920
    v_mfma_f32_16x16x32_bf16 v[40:43], v[52:55], v[100:103], v[40:43]
    ds_read_b64 v[126:127], v8 offset:1928
    v_mfma_f32_16x16x32_bf16 v[40:43], v[84:87], v[68:71], v[40:43]
    ds_read_b128 v[140:143], v9 offset:2240
    v_mfma_f32_16x16x32_bf16 v[44:47], v[52:55], v[104:107], v[44:47]
    v_mfma_f32_16x16x32_bf16 v[44:47], v[88:91], v[68:71], v[44:47]
    v_mfma_f32_16x16x32_bf16 v[40:43], v[56:59], v[96:99], v[40:43]
    v_mfma_f32_16x16x32_bf16 v[40:43], v[80:83], v[72:75], v[40:43]
    v_mfma_f32_16x16x32_bf16 v[44:47], v[56:59], v[100:103], v[44:47]
    v_mfma_f32_16x16x32_bf16 v[44:47], v[84:87], v[72:75], v[44:47]
    v_mfma_f32_16x16x32_bf16 v[44:47], v[60:63], v[96:99], v[44:47]
    v_mfma_f32_16x16x32_bf16 v[44:47], v[80:83], v[76:79], v[44:47]
    s_waitcnt lgkmcnt(0)
    v_mfma_f32_16x16x32_bf16 v[16:19], v[112:115], v[128:131], v[16:19]
    ds_read_b64 v[48:49], v8 offset:2432
    v_mfma_f32_16x16x32_bf16 v[20:23], v[112:115], v[132:135], v[20:23]
    ds_read_b64 v[50:51], v8 offset:2440
    v_mfma_f32_16x16x32_bf16 v[24:27], v[112:115], v[136:139], v[24:27]
    ds_read_b128 v[64:67], v9 offset:1728
    v_mfma_f32_16x16x32_bf16 v[28:31], v[112:115], v[140:143], v[28:31]
    ds_read_b64 v[52:53], v8 offset:2944
    v_mfma_f32_16x16x32_bf16 v[20:23], v[116:119], v[128:131], v[20:23]
    ds_read_b64 v[54:55], v8 offset:2952
    v_mfma_f32_16x16x32_bf16 v[24:27], v[116:119], v[132:135], v[24:27]
    ds_read_b128 v[68:71], v9 offset:1216
    v_mfma_f32_16x16x32_bf16 v[28:31], v[116:119], v[136:139], v[28:31]
    ds_read_b64 v[56:57], v8 offset:3456
    v_mfma_f32_16x16x32_bf16 v[32:35], v[116:119], v[140:143], v[32:35]
    ds_read_b64 v[58:59], v8 offset:3464
    v_mfma_f32_16x16x32_bf16 v[24:27], v[120:123], v[128:131], v[24:27]
    ds_read_b128 v[72:75], v9 offset:704
    v_mfma_f32_16x16x32_bf16 v[28:31], v[120:123], v[132:135], v[28:31]
    ds_read_b64 v[60:61], v8 offset:3968
    v_mfma_f32_16x16x32_bf16 v[32:35], v[120:123], v[136:139], v[32:35]
    ds_read_b64 v[62:63], v8 offset:3976
    v_mfma_f32_16x16x32_bf16 v[36:39], v[120:123], v[140:143], v[36:39]
    ds_read_b128 v[76:79], v9 offset:192
    v_mfma_f32_16x16x32_bf16 v[28:31], v[124:127], v[128:131], v[28:31]
    v_mfma_f32_16x16x32_bf16 v[32:35], v[124:127], v[132:135], v[32:35]
    v_mfma_f32_16x16x32_bf16 v[36:39], v[124:127], v[136:139], v[36:39]
    v_mfma_f32_16x16x32_bf16 v[40:43], v[124:127], v[140:143], v[40:43]
    s_waitcnt lgkmcnt(0)
    ds_write_b32 v3, v15 offset:64
    v_mfma_f32_16x16x32_bf16 v[32:35], v[48:51], v[128:131], v[32:35]
    s_lshl_b32 s73, s48, 13
    v_mfma_f32_16x16x32_bf16 v[32:35], v[112:115], v[64:67], v[32:35]
    s_add_u32 s73, s73, 114688
    v_mfma_f32_16x16x32_bf16 v[36:39], v[48:51], v[132:135], v[36:39]
    v_add_u32 v8, s73, v2
    v_mfma_f32_16x16x32_bf16 v[36:39], v[116:119], v[64:67], v[36:39]
    s_lshl_b32 s73, s48, 11
    v_mfma_f32_16x16x32_bf16 v[40:43], v[48:51], v[136:139], v[40:43]
    s_add_u32 s73, s73, 114688
    v_mfma_f32_16x16x32_bf16 v[40:43], v[120:123], v[64:67], v[40:43]
    v_add_u32 v5, s73, v2
    v_mfma_f32_16x16x32_bf16 v[44:47], v[48:51], v[140:143], v[44:47]
    v_lshrrev_b32 v9, 1, v12
    v_mfma_f32_16x16x32_bf16 v[44:47], v[124:127], v[64:67], v[44:47]
    v_lshlrev_b32 v9, 7, v9
    v_mfma_f32_16x16x32_bf16 v[36:39], v[52:55], v[128:131], v[36:39]
    v_lshl_add_u32 v9, v13, 5, v9
    v_mfma_f32_16x16x32_bf16 v[36:39], v[112:115], v[68:71], v[36:39]
    v_lshl_add_u32 v9, v14, 4, v9
    v_mfma_f32_16x16x32_bf16 v[40:43], v[52:55], v[132:135], v[40:43]
    s_lshl_b32 s73, s74, 13
    v_mfma_f32_16x16x32_bf16 v[40:43], v[116:119], v[68:71], v[40:43]
    s_lshl_b32 s58, s48, 11
    v_mfma_f32_16x16x32_bf16 v[44:47], v[52:55], v[136:139], v[44:47]
    s_add_u32 s73, s73, s58
    v_mfma_f32_16x16x32_bf16 v[44:47], v[120:123], v[68:71], v[44:47]
    s_add_u32 s73, s73, 2097152
    v_mfma_f32_16x16x32_bf16 v[40:43], v[56:59], v[128:131], v[40:43]
    ds_read_b32 v10, v0 offset:64
    v_mfma_f32_16x16x32_bf16 v[40:43], v[112:115], v[72:75], v[40:43]
    v_mfma_f32_16x16x32_bf16 v[44:47], v[56:59], v[132:135], v[44:47]
    v_mfma_f32_16x16x32_bf16 v[44:47], v[116:119], v[72:75], v[44:47]
    v_mfma_f32_16x16x32_bf16 v[44:47], v[60:63], v[128:131], v[44:47]
    v_mfma_f32_16x16x32_bf16 v[44:47], v[112:115], v[76:79], v[44:47]
    s_waitcnt lgkmcnt(0)
    s_nop 3
    v_cmp_ne_u32 vcc, s78, v10
    s_cbranch_vccz L_lwd11
    s_mov_b32 s58, 0
L_lw11:
    ds_read_b32 v10, v0 offset:64
    s_waitcnt lgkmcnt(0)
    v_cmp_ne_u32 vcc, s78, v10
    s_cbranch_vccz L_lwd11
    s_add_u32 s58, s58, 1
    s_cmp_lt_u32 s58, 0x400000
    s_cbranch_scc0 L_lwd11
    s_sleep 1
    s_branch L_lw11
L_lwd11:
    ds_write_b128 v8, v[16:19] offset:0
    ds_write_b128 v8, v[20:23] offset:1024
    ds_write_b128 v8, v[24:27] offset:2048
    ds_write_b128 v8, v[28:31] offset:3072
    ds_write_b128 v8, v[32:35] offset:4096
    ds_write_b128 v8, v[36:39] offset:5120
    ds_write_b128 v8, v[40:43] offset:6144
    ds_write_b128 v8, v[44:47] offset:7168
    ds_write_b32 v3, v15 offset:80
    s_mul_i32 s62, s51, 114688
    s_add_u32 s62, s62, 4194304
    s_lshl_b32 s64, s51, 7
    s_lshl_b32 s58, s48, 5
    s_add_u32 s64, s64, s58
    s_add_u32 s64, s64, 16384
    s_lshr_b32 s65, s74, 5
    s_lshl_b32 s65, s65, 9
    s_lshl_b32 s58, s48, 7
    s_add_u32 s65, s65, s58
    s_and_b32 s58, s74, 31
    s_lshl_b32 s58, s58, 2
    s_add_u32 s65, s65, s58
    s_add_u32 s65, s65, 24576
    s_mov_b32 s58, 0
L_lw12:
    ds_read_b32 v10, v0 offset:80
    s_waitcnt lgkmcnt(0)
    v_cmp_ne_u32 vcc, s78, v10
    s_cbranch_vccz L_lwd12
    s_add_u32 s58, s58, 1
    s_cmp_lt_u32 s58, 0x400000
    s_cbranch_scc0 L_lwd12
    s_sleep 1
    s_branch L_lw12
L_lwd12:
    ds_read_b128 v[112:115], v5 offset:0
    ds_read_b128 v[116:119], v5 offset:8192
    ds_read_b128 v[120:123], v5 offset:16384
    ds_read_b128 v[124:127], v5 offset:24576
    ds_read_b128 v[128:131], v5 offset:1024
    ds_read_b128 v[132:135], v5 offset:9216
    ds_read_b128 v[136:139], v5 offset:17408
    ds_read_b128 v[140:143], v5 offset:25600
    ds_write_b32 v3, v15 offset:96
    s_mov_b32 s58, 0
L_sp13:
    s_load_dwordx8 s[8:15], s[44:45], s64 glc
    s_waitcnt lgkmcnt(0)
    s_mov_b32 s15, s78
    s_xor_b64 s[8:9], s[8:9], s[78:79]
    s_xor_b64 s[10:11], s[10:11], s[78:79]
    s_xor_b64 s[12:13], s[12:13], s[78:79]
    s_xor_b64 s[14:15], s[14:15], s[78:79]
    s_or_b64 s[8:9], s[8:9], s[10:11]
    s_or_b64 s[12:13], s[12:13], s[14:15]
    s_or_b64 s[8:9], s[8:9], s[12:13]
    s_cbranch_scc0 L_spd13
    s_add_u32 s58, s58, 1
    s_cmp_lt_u32 s58, 0x40000
    s_sleep 8
    s_cbranch_scc1 L_sp13
L_spd13:
    v_add_f32 v112, v112, v120
    v_add_f32 v116, v116, v124
    v_add_f32 v113, v113, v121
    v_add_f32 v117, v117, v125
    v_add_f32 v114, v114, v122
    v_add_f32 v118, v118, v126
    v_add_f32 v115, v115, v123
    v_add_f32 v119, v119, v127
    v_cvt_pk_bf16_f32 v120, v112, v116
    v_cvt_pk_bf16_f32 v121, v113, v117
    v_cvt_pk_bf16_f32 v122, v114, v118
    v_cvt_pk_bf16_f32 v123, v115, v119
    buffer_store_dwordx4 v[120:123], v9, s[44:47], s73 offen offset:0 sc1
    v_add_f32 v128, v128, v136
    v_add_f32 v132, v132, v140
    v_add_f32 v129, v129, v137
    v_add_f32 v133, v133, v141
    v_add_f32 v130, v130, v138
    v_add_f32 v134, v134, v142
    v_add_f32 v131, v131, v139
    v_add_f32 v135, v135, v143
    v_cvt_pk_bf16_f32 v136, v128, v132
    v_cvt_pk_bf16_f32 v137, v129, v133
    v_cvt_pk_bf16_f32 v138, v130, v134
    v_cvt_pk_bf16_f32 v139, v131, v135
    buffer_store_dwordx4 v[136:139], v9, s[44:47], s73 offen offset:1024 sc1
    s_add_u32 s58, s3, 0
    s_cmp_ge_u32 s58, 7
    s_cselect_b32 s59, 7, 0
    s_sub_u32 s58, s58, s59
    s_mul_i32 s59, s48, 7
    s_add_u32 s58, s58, s59
    s_lshl_b32 s63, s58, 11
    s_add_u32 s63, s63, s62
    s_add_u32 s61, s63, 57344
    buffer_load_dwordx4 v[48:51], v2, s[44:47], s63 offen offset:0 sc1
    buffer_load_dwordx4 v[52:55], v2, s[44:47], s61 offen offset:0 sc1
    buffer_load_dwordx4 v[56:59], v2, s[44:47], s63 offen offset:1024 sc1
    buffer_load_dwordx4 v[60:63], v2, s[44:47], s61 offen offset:1024 sc1
    s_add_u32 s58, s3, 1
    s_cmp_ge_u32 s58, 7
    s_cselect_b32 s59, 7, 0
    s_sub_u32 s58, s58, s59
    s_mul_i32 s59, s48, 7
    s_add_u32 s58, s58, s59
    s_lshl_b32 s63, s58, 11
    s_add_u32 s63, s63, s62
    s_add_u32 s61, s63, 57344
    buffer_load_dwordx4 v[64:67], v2, s[44:47], s63 offen offset:0 sc1
    buffer_load_dwordx4 v[68:71], v2, s[44:47], s61 offen offset:0 sc1
    buffer_load_dwordx4 v[72:75], v2, s[44:47], s63 offen offset:1024 sc1
    buffer_load_dwordx4 v[76:79], v2, s[44:47], s61 offen offset:1024 sc1
    v_bfe_u32 v8, v1, 2, 2
    v_lshrrev_b32 v9, 5, v1
    v_lshl_add_u32 v10, v9, 2, v8
    v_lshlrev_b32 v10, 7, v10
    v_bfe_u32 v9, v1, 4, 1
    v_lshl_add_u32 v10, v9, 5, v10
    v_and_b32 v9, 3, v1
    v_lshl_add_u32 v10, v9, 3, v10
    v_add_u32 v10, s57, v10
    v_lshrrev_b32 v8, 1, v8
    v_lshl_add_u32 v4, v8, 6, v10
    v_xor_b32 v8, 1, v8
    v_lshl_add_u32 v5, v8, 6, v10
    v_add_u32 v6, 0x10000, v4
    v_add_u32 v7, 0x10000, v5
    s_mov_b32 s58, 0
L_lw14:
    ds_read_b32 v10, v3 offset:16
    s_waitcnt lgkmcnt(0)
    v_cmp_ne_u32 vcc, s78, v10
    s_cbranch_vccz L_lwd14
    s_add_u32 s58, s58, 1
    s_cmp_lt_u32 s58, 0x400000
    s_cbranch_scc0 L_lwd14
    s_sleep 1
    s_branch L_lw14
L_lwd14:
    ds_read_b64_tr_b16 v[144:145], v6 offset:32768
    ds_read_b64_tr_b16 v[146:147], v6 offset:33792
    ds_read_b64_tr_b16 v[148:149], v7 offset:32768
    ds_read_b64_tr_b16 v[150:151], v7 offset:33792
    ds_read_b64_tr_b16 v[152:153], v6 offset:34816
    ds_read_b64_tr_b16 v[154:155], v6 offset:35840
    ds_read_b64_tr_b16 v[156:157], v7 offset:34816
    ds_read_b64_tr_b16 v[158:159], v7 offset:35840
    ds_read_b64_tr_b16 v[160:161], v4 offset:0
    ds_read_b64_tr_b16 v[162:163], v4 offset:1024
    ds_read_b64_tr_b16 v[164:165], v5 offset:0
    ds_read_b64_tr_b16 v[166:167], v5 offset:1024
    ds_read_b64_tr_b16 v[168:169], v4 offset:2048
    ds_read_b64_tr_b16 v[170:171], v4 offset:3072
    ds_read_b64_tr_b16 v[172:173], v5 offset:2048
    ds_read_b64_tr_b16 v[174:175], v5 offset:3072
    ds_read_b64_tr_b16 v[176:177], v4 offset:16384
    ds_read_b64_tr_b16 v[178:179], v4 offset:17408
    ds_read_b64_tr_b16 v[180:181], v5 offset:16384
    ds_read_b64_tr_b16 v[182:183], v5 offset:17408
    ds_read_b64_tr_b16 v[184:185], v4 offset:18432
    ds_read_b64_tr_b16 v[186:187], v4 offset:19456
    ds_read_b64_tr_b16 v[188:189], v5 offset:18432
    ds_read_b64_tr_b16 v[190:191], v5 offset:19456
    ds_read_b64_tr_b16 v[192:193], v4 offset:32768
    ds_read_b64_tr_b16 v[194:195], v4 offset:33792
    ds_read_b64_tr_b16 v[196:197], v5 offset:32768
    ds_read_b64_tr_b16 v[198:199], v5 offset:33792
    ds_read_b64_tr_b16 v[200:201], v4 offset:34816
    ds_read_b64_tr_b16 v[202:203], v4 offset:35840
    ds_read_b64_tr_b16 v[204:205], v5 offset:34816
    ds_read_b64_tr_b16 v[206:207], v5 offset:35840
    ds_read_b64_tr_b16 v[208:209], v4 offset:49152
    ds_read_b64_tr_b16 v[210:211], v4 offset:50176
    ds_read_b64_tr_b16 v[212:213], v5 offset:49152
    ds_read_b64_tr_b16 v[214:215], v5 offset:50176
    ds_read_b64_tr_b16 v[216:217], v4 offset:51200
    ds_read_b64_tr_b16 v[218:219], v4 offset:52224
    ds_read_b64_tr_b16 v[220:221], v5 offset:51200
    ds_read_b64_tr_b16 v[222:223], v5 offset:52224
    ds_read_b64_tr_b16 v[224:225], v6 offset:0
    ds_read_b64_tr_b16 v[226:227], v6 offset:1024
    ds_read_b64_tr_b16 v[228:229], v7 offset:0
    ds_read_b64_tr_b16 v[230:231], v7 offset:1024
    ds_read_b64_tr_b16 v[232:233], v6 offset:2048
    ds_read_b64_tr_b16 v[234:235], v6 offset:3072
    ds_read_b64_tr_b16 v[236:237], v7 offset:2048
    ds_read_b64_tr_b16 v[238:239], v7 offset:3072
    ds_read_b64_tr_b16 v[240:241], v6 offset:16384
    ds_read_b64_tr_b16 v[242:243], v6 offset:17408
    ds_read_b64_tr_b16 v[244:245], v7 offset:16384
    ds_read_b64_tr_b16 v[246:247], v7 offset:17408
    ds_read_b64_tr_b16 v[248:249], v6 offset:18432
    ds_read_b64_tr_b16 v[250:251], v6 offset:19456
    ds_read_b64_tr_b16 v[252:253], v7 offset:18432
    ds_read_b64_tr_b16 v[254:255], v7 offset:19456
    ds_write_b32 v3, v15 offset:32
    ds_read_b32 v11, v0 offset:96
    s_waitcnt vmcnt(8)
    v_mov_b32 v8, 0
    v_mov_b32 v9, s78
    s_mov_b64 exec, 1
    buffer_store_dword v9, v8, s[44:47], s65 offen sc1
    s_mov_b64 exec, -1
    s_add_u32 s58, s3, 2
    s_cmp_ge_u32 s58, 7
    s_cselect_b32 s59, 7, 0
    s_sub_u32 s58, s58, s59
    s_mul_i32 s59, s48, 7
    s_add_u32 s58, s58, s59
    s_lshl_b32 s63, s58, 11
    s_add_u32 s63, s63, s62
    s_add_u32 s61, s63, 57344
    buffer_load_dwordx4 v[80:83], v2, s[44:47], s63 offen offset:0 sc1
    buffer_load_dwordx4 v[84:87], v2, s[44:47], s61 offen offset:0 sc1
    buffer_load_dwordx4 v[88:91], v2, s[44:47], s63 offen offset:1024 sc1
    buffer_load_dwordx4 v[92:95], v2, s[44:47], s61 offen offset:1024 sc1
    s_add_u32 s58, s3, 3
    s_cmp_ge_u32 s58, 7
    s_cselect_b32 s59, 7, 0
    s_sub_u32 s58, s58, s59
    s_mul_i32 s59, s48, 7
    s_add_u32 s58, s58, s59
    s_lshl_b32 s63, s58, 11
    s_add_u32 s63, s63, s62
    s_add_u32 s61, s63, 57344
    buffer_load_dwordx4 v[96:99], v2, s[44:47], s63 offen offset:0 sc1
    buffer_load_dwordx4 v[100:103], v2, s[44:47], s61 offen offset:0 sc1
    buffer_load_dwordx4 v[104:107], v2, s[44:47], s63 offen offset:1024 sc1
    buffer_load_dwordx4 v[108:111], v2, s[44:47], s61 offen offset:1024 sc1
    s_waitcnt lgkmcnt(0)
    s_waitcnt vmcnt(16)
    v_mfma_f32_32x32x16_bf16 v[112:127], v[144:147], v[48:51], 0
    v_mfma_f32_32x32x16_bf16 v[16:31], v[148:151], v[48:51], 0
    s_waitcnt vmcnt(15)
    v_mfma_f32_32x32x16_bf16 v[128:143], v[144:147], v[52:55], 0
    v_mfma_f32_32x32x16_bf16 v[32:47], v[148:151], v[52:55], 0
    s_add_u32 s58, s3, 4
    s_cmp_ge_u32 s58, 7
    s_cselect_b32 s59, 7, 0
    s_sub_u32 s58, s58, s59
    s_mul_i32 s59, s48, 7
    s_add_u32 s58, s58, s59
    s_lshl_b32 s63, s58, 11
    s_add_u32 s63, s63, s62
    s_add_u32 s61, s63, 57344
    buffer_load_dwordx4 v[48:51], v2, s[44:47], s63 offen offset:0 sc1
    s_waitcnt vmcnt(15)
    v_mfma_f32_32x32x16_bf16 v[112:127], v[152:155], v[56:59], v[112:127]
    v_mfma_f32_32x32x16_bf16 v[16:31], v[156:159], v[56:59], v[16:31]
    buffer_load_dwordx4 v[52:55], v2, s[44:47], s61 offen offset:0 sc1
    s_waitcnt vmcnt(15)
    v_mfma_f32_32x32x16_bf16 v[128:143], v[152:155], v[60:63], v[128:143]
    v_mfma_f32_32x32x16_bf16 v[32:47], v[156:159], v[60:63], v[32:47]
    buffer_load_dwordx4 v[56:59], v2, s[44:47], s63 offen offset:1024 sc1
    s_waitcnt vmcnt(15)
    v_mfma_f32_32x32x16_bf16 v[112:127], v[160:163], v[64:67], v[112:127]
    v_mfma_f32_32x32x16_bf16 v[16:31], v[164:167], v[64:67], v[16:31]
    buffer_load_dwordx4 v[60:63], v2, s[44:47], s61 offen offset:1024 sc1
    s_waitcnt vmcnt(15)
    v_mfma_f32_32x32x16_bf16 v[128:143], v[160:163], v[68:71], v[128:143]
    v_mfma_f32_32x32x16_bf16 v[32:47], v[164:167], v[68:71], v[32:47]
    s_add_u32 s58, s3, 5
    s_cmp_ge_u32 s58, 7
    s_cselect_b32 s59, 7, 0
    s_sub_u32 s58, s58, s59
    s_mul_i32 s59, s48, 7
    s_add_u32 s58, s58, s59
    s_lshl_b32 s63, s58, 11
    s_add_u32 s63, s63, s62
    s_add_u32 s61, s63, 57344
    buffer_load_dwordx4 v[64:67], v2, s[44:47], s63 offen offset:0 sc1
    s_waitcnt vmcnt(15)
    v_mfma_f32_32x32x16_bf16 v[112:127], v[168:171], v[72:75], v[112:127]
    v_mfma_f32_32x32x16_bf16 v[16:31], v[172:175], v[72:75], v[16:31]
    buffer_load_dwordx4 v[68:71], v2, s[44:47], s61 offen offset:0 sc1
    s_waitcnt vmcnt(15)
    v_mfma_f32_32x32x16_bf16 v[128:143], v[168:171], v[76:79], v[128:143]
    v_mfma_f32_32x32x16_bf16 v[32:47], v[172:175], v[76:79], v[32:47]
    buffer_load_dwordx4 v[72:75], v2, s[44:47], s63 offen offset:1024 sc1
    s_waitcnt vmcnt(14)
    v_mfma_f32_32x32x16_bf16 v[112:127], v[176:179], v[80:83], v[112:127]
    v_mfma_f32_32x32x16_bf16 v[16:31], v[180:183], v[80:83], v[16:31]
    buffer_load_dwordx4 v[76:79], v2, s[44:47], s61 offen offset:1024 sc1
    s_waitcnt vmcnt(14)
    v_mfma_f32_32x32x16_bf16 v[128:143], v[176:179], v[84:87], v[128:143]
    v_mfma_f32_32x32x16_bf16 v[32:47], v[180:183], v[84:87], v[32:47]
    s_add_u32 s58, s3, 6
    s_cmp_ge_u32 s58, 7
    s_cselect_b32 s59, 7, 0
    s_sub_u32 s58, s58, s59
    s_mul_i32 s59, s48, 7
    s_add_u32 s58, s58, s59
    s_lshl_b32 s63, s58, 11
    s_add_u32 s63, s63, s62
    s_add_u32 s61, s63, 57344
    buffer_load_dwordx4 v[80:83], v2, s[44:47], s63 offen offset:0 sc1
    s_waitcnt vmcnt(14)
    v_mfma_f32_32x32x16_bf16 v[112:127], v[184:187], v[88:91], v[112:127]
    v_mfma_f32_32x32x16_bf16 v[16:31], v[188:191], v[88:91], v[16:31]
    buffer_load_dwordx4 v[84:87], v2, s[44:47], s61 offen offset:0 sc1
    s_waitcnt vmcnt(14)
    v_mfma_f32_32x32x16_bf16 v[128:143], v[184:187], v[92:95], v[128:143]
    v_mfma_f32_32x32x16_bf16 v[32:47], v[188:191], v[92:95], v[32:47]
    buffer_load_dwordx4 v[88:91], v2, s[44:47], s63 offen offset:1024 sc1
    s_waitcnt vmcnt(14)
    v_mfma_f32_32x32x16_bf16 v[112:127], v[192:195], v[96:99], v[112:127]
    v_mfma_f32_32x32x16_bf16 v[16:31], v[196:199], v[96:99], v[16:31]
    buffer_load_dwordx4 v[92:95], v2, s[44:47], s61 offen offset:1024 sc1
    s_waitcnt vmcnt(14)
    v_mfma_f32_32x32x16_bf16 v[128:143], v[192:195], v[100:103], v[128:143]
    v_mfma_f32_32x32x16_bf16 v[32:47], v[196:199], v[100:103], v[32:47]
    s_waitcnt vmcnt(13)
    v_mfma_f32_32x32x16_bf16 v[112:127], v[200:203], v[104:107], v[112:127]
    v_mfma_f32_32x32x16_bf16 v[16:31], v[204:207], v[104:107], v[16:31]
    s_waitcnt vmcnt(12)
    v_mfma_f32_32x32x16_bf16 v[128:143], v[200:203], v[108:111], v[128:143]
    v_mfma_f32_32x32x16_bf16 v[32:47], v[204:207], v[108:111], v[32:47]
    s_waitcnt vmcnt(11)
    v_mfma_f32_32x32x16_bf16 v[112:127], v[208:211], v[48:51], v[112:127]
    v_mfma_f32_32x32x16_bf16 v[16:31], v[212:215], v[48:51], v[16:31]
    s_waitcnt vmcnt(10)
    v_mfma_f32_32x32x16_bf16 v[128:143], v[208:211], v[52:55], v[128:143]
    v_mfma_f32_32x32x16_bf16 v[32:47], v[212:215], v[52:55], v[32:47]
    s_waitcnt vmcnt(9)
    v_mfma_f32_32x32x16_bf16 v[112:127], v[216:219], v[56:59], v[112:127]
    v_mfma_f32_32x32x16_bf16 v[16:31], v[220:223], v[56:59], v[16:31]
    s_waitcnt vmcnt(8)
    v_mfma_f32_32x32x16_bf16 v[128:143], v[216:219], v[60:63], v[128:143]
    v_mfma_f32_32x32x16_bf16 v[32:47], v[220:223], v[60:63], v[32:47]
    s_waitcnt vmcnt(7)
    v_mfma_f32_32x32x16_bf16 v[112:127], v[224:227], v[64:67], v[112:127]
    v_mfma_f32_32x32x16_bf16 v[16:31], v[228:231], v[64:67], v[16:31]
    s_waitcnt vmcnt(6)
    v_mfma_f32_32x32x16_bf16 v[128:143], v[224:227], v[68:71], v[128:143]
    v_mfma_f32_32x32x16_bf16 v[32:47], v[228:231], v[68:71], v[32:47]
    s_waitcnt vmcnt(5)
    v_mfma_f32_32x32x16_bf16 v[112:127], v[232:235], v[72:75], v[112:127]
    v_mfma_f32_32x32x16_bf16 v[16:31], v[236:239], v[72:75], v[16:31]
    s_waitcnt vmcnt(4)
    v_mfma_f32_32x32x16_bf16 v[128:143], v[232:235], v[76:79], v[128:143]
    v_mfma_f32_32x32x16_bf16 v[32:47], v[236:239], v[76:79], v[32:47]
    s_waitcnt vmcnt(3)
    v_mfma_f32_32x32x16_bf16 v[112:127], v[240:243], v[80:83], v[112:127]
    v_mfma_f32_32x32x16_bf16 v[16:31], v[244:247], v[80:83], v[16:31]
    s_waitcnt vmcnt(2)
    v_mfma_f32_32x32x16_bf16 v[128:143], v[240:243], v[84:87], v[128:143]
    v_mfma_f32_32x32x16_bf16 v[32:47], v[244:247], v[84:87], v[32:47]
    s_waitcnt vmcnt(1)
    v_mfma_f32_32x32x16_bf16 v[112:127], v[248:251], v[88:91], v[112:127]
    v_mfma_f32_32x32x16_bf16 v[16:31], v[252:255], v[88:91], v[16:31]
    s_waitcnt vmcnt(0)
    v_mfma_f32_32x32x16_bf16 v[128:143], v[248:251], v[92:95], v[128:143]
    v_mfma_f32_32x32x16_bf16 v[32:47], v[252:255], v[92:95], v[32:47]
    s_nop 7
    v_cmp_ne_u32 vcc, s78, v11
    s_cbranch_vccz L_lwd15
    s_mov_b32 s58, 0
L_lw15:
    ds_read_b32 v11, v0 offset:96
    s_waitcnt lgkmcnt(0)
    v_cmp_ne_u32 vcc, s78, v11
    s_cbranch_vccz L_lwd15
    s_add_u32 s58, s58, 1
    s_cmp_lt_u32 s58, 0x400000
    s_cbranch_scc0 L_lwd15
    s_sleep 1
    s_branch L_lw15
L_lwd15:
    v_add_u32 v9, s57, v2
    v_add_u32 v9, 0x10000, v9
    ds_write_b128 v9, v[112:115] offset:0
    ds_write_b128 v9, v[116:119] offset:1024
    ds_write_b128 v9, v[120:123] offset:16384
    ds_write_b128 v9, v[124:127] offset:17408
    ds_write_b128 v9, v[16:19] offset:32768
    ds_write_b128 v9, v[20:23] offset:33792
    ds_write_b128 v9, v[24:27] offset:49152
    ds_write_b128 v9, v[28:31] offset:50176
    ds_write_b128 v9, v[128:131] offset:2048
    ds_write_b128 v9, v[132:135] offset:3072
    ds_write_b128 v9, v[136:139] offset:18432
    ds_write_b128 v9, v[140:143] offset:19456
    ds_write_b128 v9, v[32:35] offset:34816
    ds_write_b128 v9, v[36:39] offset:35840
    ds_write_b128 v9, v[40:43] offset:51200
    ds_write_b128 v9, v[44:47] offset:52224
    ds_write_b32 v3, v15 offset:128
L_fin:
L_end:
    s_endpgm
.section .rodata,"a"
.p2align 6
.amdhsa_kernel parallel_sum__ssm_conv_h3__glu_gated_swiglu__prompt_kernel
  .amdhsa_next_free_vgpr 256
  .amdhsa_next_free_sgpr 102
  .amdhsa_accum_offset 256
  .amdhsa_group_segment_fixed_size 0
  .amdhsa_kernarg_size 104
  .amdhsa_user_sgpr_count 2
  .amdhsa_user_sgpr_kernarg_segment_ptr 1
  .amdhsa_system_sgpr_workgroup_id_x 1
  .amdhsa_float_denorm_mode_32 3
.end_amdhsa_kernel
```
